```python
import torch

def _softmax(x, axis=-1):
    return torch.softmax(x, dim=axis)
def _gelu(x):
    return torch.nn.functional.gelu(x, approximate="tanh")
def _silu(x):
    return torch.nn.functional.silu(x)
def _sigmoid(x):
    return torch.sigmoid(x)
def _layernorm(x, axis=-1, eps=1e-5):
    m = x.mean(dim=axis, keepdim=True)
    v = x.var(dim=axis, keepdim=True, unbiased=False)
    return (x - m) / torch.sqrt(v + eps)
def _scatter_add(tgt, idx, src, axis=0):
    return tgt.clone().index_add_(axis, idx, src)
def _segment_sum(src, seg, n):
    out = torch.zeros((n,) + src.shape[1:], dtype=src.dtype)
    return out.index_add_(0, seg, src)
def _pad(x, pw):
    flat = tuple(v for pair in reversed(pw) for v in pair)
    return torch.nn.functional.pad(x, flat)

kernel_name = 'interleave_layers__mha_block_cached__glu_gated_reglu__decode'

def setup_inputs():

    _w = (lambda a: (lambda t: t.to(torch.bfloat16) if t.is_floating_point() else t)(torch.as_tensor(a)))
    def _A_setup():
        B, Sq, D = 2, 1, 448
        H, Sk, Dh = 16, 4096, 256
        return {
            "x": _w((lambda *s: torch.randn(*s, dtype=torch.bfloat16) * 0.05)(B, Sq, D)),
            "k_cache": _w((lambda *s: torch.randn(*s, dtype=torch.bfloat16) * 1.6)(B, H, Sk, Dh)),
            "v_cache": _w((lambda *s: torch.randn(*s, dtype=torch.bfloat16) * 0.8)(B, H, Sk, Dh)),
            "wq": _w((lambda *s: torch.randn(*s, dtype=torch.bfloat16) * 1.6)(D, H * Dh) * (D ** -0.5)),
            "wo": _w((lambda *s: torch.randn(*s, dtype=torch.bfloat16) * 0.8)(H * Dh, D) * ((H * Dh) ** -0.5)),
        }
    _A_in = _A_setup()

    def _B_setup():
        B, S, D, F = 2, 1, 448, 1792
        return {
            "x": _w((lambda *s: torch.randn(*s, dtype=torch.bfloat16) * 0.05)(B, S, D)),
            "W_gate": _w((lambda *s: torch.randn(*s, dtype=torch.bfloat16) * 0.4)(D, F) * (2.0 / D) ** 0.5),
            "W_up": _w((lambda *s: torch.randn(*s, dtype=torch.bfloat16) * 0.4)(D, F) * (2.0 / D) ** 0.5),
            "W_down": _w((lambda *s: torch.randn(*s, dtype=torch.bfloat16) * 0.4)(F, D) * (1.0 / F) ** 0.5),
        }
    _B_in = _B_setup()

    return {
        "A_x": _A_in["x"],
        "A_k_cache": _A_in["k_cache"],
        "A_v_cache": _A_in["v_cache"],
        "A_wq": _A_in["wq"],
        "A_wo": _A_in["wo"],
        "B_x": _B_in["x"],
        "B_W_gate": _B_in["W_gate"],
        "B_W_up": _B_in["W_up"],
        "B_W_down": _B_in["W_down"],
    }

def reference(A_x, A_k_cache, A_v_cache, A_wq, A_wo, B_x, B_W_gate, B_W_up, B_W_down):
    def _A_ref(x, k_cache, v_cache, wq, wo):
        B, Sq, D = x.shape
        H, Dh = 16, 256
        q = (lambda x, *d: x.permute(*d))((x @ wq).reshape(B, Sq, H, Dh), 0, 2, 1, 3)
        scores = torch.einsum("bhqd,bhkd->bhqk", q, k_cache) * (Dh ** -0.5)
        p = _softmax(scores, axis=-1)
        o = torch.einsum("bhqk,bhkd->bhqd", p, v_cache)
        return (lambda x, *d: x.permute(*d))(o, 0, 2, 1, 3).reshape(B, Sq, H * Dh) @ wo

    def _B_ref(x, W_gate, W_up, W_down):
        gate = torch.einsum("bsd,df->bsf", x, W_gate)
        up = torch.einsum("bsd,df->bsf", x, W_up)
        gate = gate * (lambda x, dt: x.to(dt))(gate > 0, gate.dtype)
        h = gate * up
        return torch.einsum("bsf,fd->bsd", h, W_down)

    x = A_x
    x = x + _A_ref(_layernorm(x, axis=-1), A_k_cache, A_v_cache, A_wq, A_wo)
    x = x + _B_ref(_layernorm(x, axis=-1), B_W_gate, B_W_up, B_W_down)
    x = x + _A_ref(_layernorm(x, axis=-1), A_k_cache, A_v_cache, A_wq, A_wo)
    x = x + _B_ref(_layernorm(x, axis=-1), B_W_gate, B_W_up, B_W_down)
    return x
```

```asm
; @launch grid=(256,1,1) block=(256,1,1) lds=163840
.amdgcn_target "amdgcn-amd-amdhsa--gfx950"
.text
.globl interleave_layers__mha_block_cached__glu_gated_reglu__decode_kernel
.p2align 8
.type interleave_layers__mha_block_cached__glu_gated_reglu__decode_kernel,@function
interleave_layers__mha_block_cached__glu_gated_reglu__decode_kernel:
s_cmp_ge_u32 s2, 256
s_cbranch_scc1 L_end
s_load_dwordx2 s[8:9], s[0:1], 8
s_load_dwordx16 s[36:51], s[0:1], 0
s_load_dwordx8 s[52:59], s[0:1], 64
v_lshrrev_b32 v1, 6, v0
v_and_b32 v0, 63, v0
s_and_b32 s27, s2, 7
v_readfirstlane_b32 s26, v1
s_lshr_b32 s28, s2, 3
s_lshr_b32 s68, s28, 3
s_and_b32 s31, s28, 7
s_and_b32 s29, s68, 1
s_lshr_b32 s30, s68, 1
s_lshl_b32 s68, s27, 1
s_add_u32 s68, s68, s29
s_lshl_b32 s69, s30, 4
s_add_u32 s68, s68, s69
s_lshl_b32 s35, s68, 21
s_lshl_b32 s68, s31, 15
s_add_u32 s35, s35, s68
s_lshl_b32 s68, s26, 13
s_add_u32 s35, s35, s68
s_mov_b32 s10, 0x4000000
s_mov_b32 s11, 0x00020000
v_lshrrev_b32 v13, 4, v0
v_and_b32 v22, 3, v0
v_lshlrev_b32 v22, 4, v22
v_lshl_add_u32 v22, v13, 6, v22
v_bfe_u32 v3, v0, 2, 2
v_lshl_add_u32 v22, v3, 11, v22
s_waitcnt lgkmcnt(0)
s_add_u32 s68, s35, 0
buffer_load_dwordx4 a[0:3], v22, s[8:11], s68 offen offset:0 nt
buffer_load_dwordx4 a[4:7], v22, s[8:11], s68 offen offset:256 nt
buffer_load_dwordx4 a[8:11], v22, s[8:11], s68 offen offset:512 nt
buffer_load_dwordx4 a[12:15], v22, s[8:11], s68 offen offset:768 nt
buffer_load_dwordx4 a[16:19], v22, s[8:11], s68 offen offset:1024 nt
buffer_load_dwordx4 a[20:23], v22, s[8:11], s68 offen offset:1280 nt
buffer_load_dwordx4 a[24:27], v22, s[8:11], s68 offen offset:1536 nt
buffer_load_dwordx4 a[28:31], v22, s[8:11], s68 offen offset:1792 nt
s_mov_b32 s33, 200000
s_mov_b32 s34, 0
s_mov_b32 s32, 0
s_mov_b32 s60, 0xffff0000
s_mov_b32 s61, 0xffff0000
v_lshlrev_b32 v2, 4, v0
v_mov_b32 v1, 0
s_mul_i32 s3, s26, 38912
v_and_b32 v12, 15, v0
v_lshlrev_b32 v23, 11, v13
v_lshl_add_u32 v23, v12, 4, v23
s_mov_b32 s6, 0
s_mov_b32 s62, s28
s_cmp_ge_u32 s28, 8
s_cselect_b32 s6, 1, s6
s_sub_u32 s68, s28, 8
s_cmp_ge_u32 s28, 8
s_cselect_b32 s62, s68, s62
s_cmp_ge_u32 s28, 15
s_cselect_b32 s6, 2, s6
s_sub_u32 s68, s28, 15
s_cmp_ge_u32 s28, 15
s_cselect_b32 s62, s68, s62
s_cmp_ge_u32 s28, 22
s_cselect_b32 s6, 3, s6
s_sub_u32 s68, s28, 22
s_cmp_ge_u32 s28, 22
s_cselect_b32 s62, s68, s62
s_cmp_ge_u32 s28, 29
s_cselect_b32 s6, 4, s6
s_sub_u32 s68, s28, 29
s_cmp_ge_u32 s28, 29
s_cselect_b32 s62, s68, s62
s_lshl_b32 s7, s62, 2
s_add_u32 s7, s7, s26
s_load_dword s46, s[58:59], 983040
s_sub_u32 s47, s7, s26
s_mov_b32 s12, s40
s_mov_b32 s13, s41
s_mov_b32 s14, 0x4000000
s_mov_b32 s15, 0x00020000
s_mov_b32 s4, s36
s_mov_b32 s5, s37
s_mov_b32 s16, s54
s_mov_b32 s17, s55
s_mov_b32 s18, s56
s_mov_b32 s19, s57
s_mov_b32 s20, s58
s_mov_b32 s21, s59
s_lshl_b32 s68, s27, 16
s_add_u32 s68, s68, 1048576
s_add_u32 s22, s58, s68
s_addc_u32 s23, s59, 0
s_add_u32 s24, s58, 1572864
s_addc_u32 s25, s59, 0
s_mov_b64 s[70:71], s[58:59]
s_mov_b64 s[72:73], s[58:59]
s_mov_b64 s[74:75], s[58:59]
s_cmp_ge_u32 s6, 3
s_cbranch_scc0 L_nogupf
s_mul_i32 s78, s7, 8
s_mul_i32 s69, s7, 20
s_add_u32 s69, s69, 224
s_cmp_eq_u32 s6, 4
s_cselect_b32 s78, s69, s78
v_lshrrev_b32 v15, 5, v0
v_mul_u32_u24 v15, 3584, v15
v_and_b32 v16, 31, v0
v_lshl_add_u32 v15, v16, 4, v15
s_mul_i32 s68, s78, 3584
s_mul_i32 s69, s27, 448
s_add_u32 s68, s68, s69
v_add_u32 v15, s68, v15
s_mov_b32 exec_lo, 0xfffffff
s_mov_b32 exec_hi, 0xfffffff
s_mov_b32 s72, s48
s_mov_b32 s73, s49
s_mov_b32 s74, 1605632
s_mov_b32 s75, 0x00020000
s_mov_b32 s69, 0
buffer_load_dwordx4 a[128:131], v15, s[72:75], s69 offen
s_mov_b32 s69, 7168
buffer_load_dwordx4 a[132:135], v15, s[72:75], s69 offen
s_mov_b32 s69, 14336
buffer_load_dwordx4 a[136:139], v15, s[72:75], s69 offen
s_mov_b32 s69, 21504
buffer_load_dwordx4 a[140:143], v15, s[72:75], s69 offen
s_mov_b32 s72, s50
s_mov_b32 s73, s51
s_mov_b32 s74, 1605632
s_mov_b32 s75, 0x00020000
s_mov_b32 s69, 0
buffer_load_dwordx4 a[144:147], v15, s[72:75], s69 offen
s_mov_b32 s69, 7168
buffer_load_dwordx4 a[148:151], v15, s[72:75], s69 offen
s_mov_b32 s69, 14336
buffer_load_dwordx4 a[152:155], v15, s[72:75], s69 offen
s_mov_b32 s69, 21504
buffer_load_dwordx4 a[156:159], v15, s[72:75], s69 offen
s_cmp_eq_u32 s6, 4
s_cbranch_scc0 L_pfgu_d
s_mov_b32 s72, s48
s_mov_b32 s73, s49
s_mov_b32 s74, 1605632
s_mov_b32 s75, 0x00020000
s_mov_b32 s69, 28672
buffer_load_dwordx4 a[160:163], v15, s[72:75], s69 offen
s_mov_b32 s69, 35840
buffer_load_dwordx4 a[164:167], v15, s[72:75], s69 offen
s_mov_b32 s69, 43008
buffer_load_dwordx4 a[168:171], v15, s[72:75], s69 offen
s_mov_b32 s69, 50176
buffer_load_dwordx4 a[172:175], v15, s[72:75], s69 offen
s_mov_b32 s69, 57344
buffer_load_dwordx4 a[176:179], v15, s[72:75], s69 offen
s_mov_b32 s69, 64512
buffer_load_dwordx4 a[180:183], v15, s[72:75], s69 offen
s_mov_b32 s72, s50
s_mov_b32 s73, s51
s_mov_b32 s74, 1605632
s_mov_b32 s75, 0x00020000
s_mov_b32 s69, 28672
buffer_load_dwordx4 a[184:187], v15, s[72:75], s69 offen
s_mov_b32 s69, 35840
buffer_load_dwordx4 a[188:191], v15, s[72:75], s69 offen
s_mov_b32 s69, 43008
buffer_load_dwordx4 a[192:195], v15, s[72:75], s69 offen
s_mov_b32 s69, 50176
buffer_load_dwordx4 a[196:199], v15, s[72:75], s69 offen
s_mov_b32 s69, 57344
buffer_load_dwordx4 a[200:203], v15, s[72:75], s69 offen
s_mov_b32 s69, 64512
buffer_load_dwordx4 a[204:207], v15, s[72:75], s69 offen
L_pfgu_d:
s_mov_b64 exec, -1
s_mov_b64 s[72:73], s[58:59]
s_mov_b64 s[74:75], s[58:59]
L_nogupf:
s_cmp_eq_u32 s6, 2
s_cselect_b32 s101, 1, 0
s_cmp_eq_u32 s101, 1
s_cbranch_scc0 L_nogu12
s_add_u32 s68, s35, 262144
buffer_load_dwordx4 a[32:35], v22, s[8:11], s68 offen offset:0 nt
buffer_load_dwordx4 a[36:39], v22, s[8:11], s68 offen offset:256 nt
buffer_load_dwordx4 a[40:43], v22, s[8:11], s68 offen offset:512 nt
buffer_load_dwordx4 a[44:47], v22, s[8:11], s68 offen offset:768 nt
buffer_load_dwordx4 a[48:51], v22, s[8:11], s68 offen offset:1024 nt
buffer_load_dwordx4 a[52:55], v22, s[8:11], s68 offen offset:1280 nt
buffer_load_dwordx4 a[56:59], v22, s[8:11], s68 offen offset:1536 nt
buffer_load_dwordx4 a[60:63], v22, s[8:11], s68 offen offset:1792 nt
s_add_u32 s68, s35, 524288
buffer_load_dwordx4 a[64:67], v22, s[8:11], s68 offen offset:0 nt
buffer_load_dwordx4 a[68:71], v22, s[8:11], s68 offen offset:256 nt
buffer_load_dwordx4 a[72:75], v22, s[8:11], s68 offen offset:512 nt
buffer_load_dwordx4 a[76:79], v22, s[8:11], s68 offen offset:768 nt
buffer_load_dwordx4 a[80:83], v22, s[8:11], s68 offen offset:1024 nt
buffer_load_dwordx4 a[84:87], v22, s[8:11], s68 offen offset:1280 nt
buffer_load_dwordx4 a[88:91], v22, s[8:11], s68 offen offset:1536 nt
buffer_load_dwordx4 a[92:95], v22, s[8:11], s68 offen offset:1792 nt
s_add_u32 s68, s35, 786432
buffer_load_dwordx4 a[96:99], v22, s[8:11], s68 offen offset:0 nt
buffer_load_dwordx4 a[100:103], v22, s[8:11], s68 offen offset:256 nt
buffer_load_dwordx4 a[104:107], v22, s[8:11], s68 offen offset:512 nt
buffer_load_dwordx4 a[108:111], v22, s[8:11], s68 offen offset:768 nt
buffer_load_dwordx4 a[112:115], v22, s[8:11], s68 offen offset:1024 nt
buffer_load_dwordx4 a[116:119], v22, s[8:11], s68 offen offset:1280 nt
buffer_load_dwordx4 a[120:123], v22, s[8:11], s68 offen offset:1536 nt
buffer_load_dwordx4 a[124:127], v22, s[8:11], s68 offen offset:1792 nt
s_waitcnt vmcnt(24)
L_nogu12:
v_lshrrev_b32 v6, 3, v0
v_and_b32 v7, 7, v0
s_cmp_eq_u32 s6, 1
s_cbranch_scc1 L_w1
s_cmp_eq_u32 s6, 2
s_cbranch_scc1 L_w2
s_cmp_eq_u32 s6, 3
s_cbranch_scc1 L_w3
s_cmp_eq_u32 s6, 0
s_cbranch_scc1 L_w0
v_mov_b32 v8, 0
s_mov_b32 s63, 0
s_mov_b32 s66, 0
s_mov_b32 s67, 0
s_mov_b32 s64, s42
s_mov_b32 s65, s43
s_mov_b32 s78, s42
s_mov_b32 s79, s43
s_branch L_wdone
L_w0:
s_mul_i32 s68, s26, 112
v_add_u32 v9, s68, v6
v_lshlrev_b32 v8, 13, v9
v_lshl_add_u32 v8, v7, 4, v8
s_lshl_b32 s68, s27, 10
s_lshl_b32 s69, s62, 7
s_add_u32 s68, s68, s69
v_add_u32 v8, s68, v8
s_mov_b32 s63, 14
s_mov_b32 s66, 65536
s_mul_i32 s67, s26, 14336
s_mov_b32 s64, s42
s_mov_b32 s65, s43
s_mov_b32 s78, s42
s_mov_b32 s79, s43
s_cmp_eq_u32 s26, 0
s_cbranch_scc0 L_nox
s_mov_b32 m0, 160384
s_nop 0
global_load_lds_dwordx4 v2, s[4:5]
s_mov_b32 exec_lo, 0xffffffff
s_mov_b32 exec_hi, 0xffff
global_load_lds_dwordx4 v2, s[4:5] offset:1024
s_mov_b64 exec, -1
L_nox:
s_branch L_wdone
L_w1:
v_and_b32 v9, 3, v6
v_lshlrev_b32 v9, 3, v9
v_lshrrev_b32 v10, 2, v6
v_add_u32 v9, v9, v10
s_lshl_b32 s68, s27, 9
s_lshl_b32 s69, s26, 7
s_add_u32 s68, s68, s69
v_add_u32 v9, s68, v9
v_mul_u32_u24 v8, 896, v9
v_lshl_add_u32 v8, v7, 4, v8
s_lshl_b32 s68, s62, 7
v_add_u32 v8, s68, v8
v_lshrrev_b32 v16, 5, v0
s_and_b32 s68, s26, 1
s_lshl_b32 s68, s68, 1
s_add_u32 s68, s68, s47
v_add_u32 v16, s68, v16
v_bfe_u32 v3, v0, 4, 1
v_mul_u32_u24 v14, 896, v3
v_lshl_add_u32 v14, v16, 5, v14
v_and_b32 v3, 15, v0
v_lshl_add_u32 v14, v3, 1, v14
global_load_ushort v1, v14, s[4:5]
s_mov_b32 s63, 16
s_mov_b32 s66, 0
s_mov_b32 s67, s3
s_mov_b32 s64, s44
s_mov_b32 s65, s45
s_mov_b32 s78, s44
s_mov_b32 s79, s45
s_branch L_wdone
L_w2:
s_mul_i32 s68, s26, 112
v_add_u32 v9, s68, v6
v_mul_u32_u24 v8, 3584, v9
v_and_b32 v10, 3, v7
v_lshl_add_u32 v8, v10, 4, v8
s_mul_i32 s68, s27, 448
s_lshl_b32 s69, s62, 6
s_add_u32 s68, s68, s69
v_add_u32 v8, s68, v8
s_mov_b32 s63, 14
s_mov_b32 s66, 28672
s_mul_i32 s67, s26, 14336
s_mov_b32 s64, s48
s_mov_b32 s65, s49
s_mov_b32 s78, s50
s_mov_b32 s79, s51
s_branch L_wdone
L_w3:
s_mul_i32 s68, s27, 224
s_mul_i32 s69, s26, 56
s_add_u32 s68, s68, s69
v_add_u32 v9, s68, v6
v_mul_u32_u24 v8, 896, v9
v_lshl_add_u32 v8, v7, 4, v8
s_lshl_b32 s68, s62, 7
v_add_u32 v8, s68, v8
s_mov_b32 s63, 7
s_mov_b32 s66, 7168
s_mul_i32 s67, s26, 7168
s_mov_b32 s64, s52
s_mov_b32 s65, s53
s_mov_b32 s78, s52
s_mov_b32 s79, s53
L_wdone:
v_cmp_le_u32 vcc, 4, v7
v_mov_b32 v4, s64
v_mov_b32 v9, s78
v_cndmask_b32 v4, v4, v9, vcc
v_mov_b32 v5, s65
v_mov_b32 v9, s79
v_cndmask_b32 v5, v5, v9, vcc
v_add_co_u32 v4, vcc, v4, v8
s_nop 1
v_addc_co_u32 v5, vcc, 0, v5, vcc
s_mov_b32 s68, s67
s_mov_b32 s69, 0
s_cmp_eq_u32 s63, 0
s_cbranch_scc1 L_wld_done
L_wld:
s_mov_b32 m0, s68
s_add_u32 s68, s68, 1024
global_load_lds_dwordx4 v[4:5], off nt
s_add_u32 s69, s69, 1
s_and_b32 s62, s69, 3
s_cmp_eq_u32 s62, 0
s_mov_b32 s76, 23296
s_cselect_b32 s62, s76, 1792
s_cmp_eq_u32 s6, 1
s_cselect_b32 s62, s62, s66
v_add_co_u32 v4, vcc, s62, v4
s_nop 1
v_addc_co_u32 v5, vcc, 0, v5, vcc
s_cmp_lt_u32 s69, s63
s_cbranch_scc1 L_wld
L_wld_done:
s_mov_b32 s48, 0x22222222
s_mov_b32 s49, 0x22222222
s_mov_b32 s50, 0x44444444
s_mov_b32 s51, 0x44444444
s_mov_b32 s52, 0x88888888
s_mov_b32 s53, 0x88888888
s_mov_b32 s54, 0x03030303
s_mov_b32 s55, 0x03030303
s_mov_b32 s56, 0x0c0c0c0c
s_mov_b32 s57, 0x0c0c0c0c
s_mov_b32 s58, 0x30303030
s_mov_b32 s59, 0x30303030
s_mov_b32 s62, 0xc0c0c0c0
s_mov_b32 s63, 0xc0c0c0c0
s_cmp_eq_u32 s26, 3
s_cbranch_scc0 L_noclr
v_mov_b32 v16, -1
v_mov_b32 v17, -1
v_mov_b32 v18, -1
v_mov_b32 v19, -1
s_lshl_b32 s68, s28, 11
v_add_u32 v12, s68, v2
global_store_dwordx4 v12, v[16:19], s[22:23] sc1
global_store_dwordx4 v12, v[16:19], s[22:23] offset:1024 sc1
s_lshl_b32 s68, s2, 12
v_add_u32 v13, s68, v2
global_store_dwordx4 v13, v[16:19], s[24:25] offset:0 sc1
global_store_dwordx4 v13, v[16:19], s[24:25] offset:1024 sc1
global_store_dwordx4 v13, v[16:19], s[24:25] offset:2048 sc1
global_store_dwordx4 v13, v[16:19], s[24:25] offset:3072 sc1
L_noclr:
s_cmp_eq_u32 s101, 1
s_cbranch_scc1 KG_1
s_add_u32 s68, s35, 262144
buffer_load_dwordx4 a[32:35], v22, s[8:11], s68 offen offset:0 nt
buffer_load_dwordx4 a[36:39], v22, s[8:11], s68 offen offset:256 nt
buffer_load_dwordx4 a[40:43], v22, s[8:11], s68 offen offset:512 nt
buffer_load_dwordx4 a[44:47], v22, s[8:11], s68 offen offset:768 nt
buffer_load_dwordx4 a[48:51], v22, s[8:11], s68 offen offset:1024 nt
buffer_load_dwordx4 a[52:55], v22, s[8:11], s68 offen offset:1280 nt
buffer_load_dwordx4 a[56:59], v22, s[8:11], s68 offen offset:1536 nt
buffer_load_dwordx4 a[60:63], v22, s[8:11], s68 offen offset:1792 nt
s_branch KD_2
KG_1:
s_add_u32 s68, s35, 1048576
buffer_load_dwordx4 a[128:131], v22, s[8:11], s68 offen offset:0 nt
buffer_load_dwordx4 a[132:135], v22, s[8:11], s68 offen offset:256 nt
buffer_load_dwordx4 a[136:139], v22, s[8:11], s68 offen offset:512 nt
buffer_load_dwordx4 a[140:143], v22, s[8:11], s68 offen offset:768 nt
buffer_load_dwordx4 a[144:147], v22, s[8:11], s68 offen offset:1024 nt
buffer_load_dwordx4 a[148:151], v22, s[8:11], s68 offen offset:1280 nt
buffer_load_dwordx4 a[152:155], v22, s[8:11], s68 offen offset:1536 nt
buffer_load_dwordx4 a[156:159], v22, s[8:11], s68 offen offset:1792 nt
KD_2:
s_waitcnt vmcnt(8) lgkmcnt(0)
s_barrier
s_cmp_eq_u32 s26, 3
s_cbranch_scc0 L_noarr
s_getreg_b32 s68, hwreg(HW_REG_XCC_ID, 0, 4)
s_and_b32 s68, s68, 7
s_mul_i32 s68, s68, 6
s_lshl_b64 s[78:79], 1, s68
s_or_b32 s79, s79, 0x01000000
v_mov_b32 v14, s78
v_mov_b32 v15, s79
s_lshl_b32 s69, s27, 5
v_mov_b32 v13, s69
s_mov_b64 exec, 1
global_atomic_add_x2 v13, v[14:15], s[18:19] sc1
s_mov_b64 exec, -1
L_noarr:
s_cmp_eq_u32 s101, 1
s_cbranch_scc1 KG_3
s_add_u32 s68, s35, 524288
buffer_load_dwordx4 a[64:67], v22, s[8:11], s68 offen offset:0 nt
buffer_load_dwordx4 a[68:71], v22, s[8:11], s68 offen offset:256 nt
buffer_load_dwordx4 a[72:75], v22, s[8:11], s68 offen offset:512 nt
buffer_load_dwordx4 a[76:79], v22, s[8:11], s68 offen offset:768 nt
buffer_load_dwordx4 a[80:83], v22, s[8:11], s68 offen offset:1024 nt
buffer_load_dwordx4 a[84:87], v22, s[8:11], s68 offen offset:1280 nt
buffer_load_dwordx4 a[88:91], v22, s[8:11], s68 offen offset:1536 nt
buffer_load_dwordx4 a[92:95], v22, s[8:11], s68 offen offset:1792 nt
s_branch KD_4
KG_3:
s_add_u32 s68, s35, 1310720
buffer_load_dwordx4 a[160:163], v22, s[8:11], s68 offen offset:0 nt
buffer_load_dwordx4 a[164:167], v22, s[8:11], s68 offen offset:256 nt
buffer_load_dwordx4 a[168:171], v22, s[8:11], s68 offen offset:512 nt
buffer_load_dwordx4 a[172:175], v22, s[8:11], s68 offen offset:768 nt
buffer_load_dwordx4 a[176:179], v22, s[8:11], s68 offen offset:1024 nt
buffer_load_dwordx4 a[180:183], v22, s[8:11], s68 offen offset:1280 nt
buffer_load_dwordx4 a[184:187], v22, s[8:11], s68 offen offset:1536 nt
buffer_load_dwordx4 a[188:191], v22, s[8:11], s68 offen offset:1792 nt
KD_4:
v_and_b32 v13, 15, v0
v_lshrrev_b32 v14, 2, v13
v_and_b32 v13, 3, v13
v_lshrrev_b32 v12, 4, v0
v_lshlrev_b32 v12, 3, v12
v_add_u32 v12, v12, v14
v_lshlrev_b32 v12, 7, v12
s_cmp_eq_u32 s6, 1
s_cbranch_scc1 L_tr_wo
s_cmp_eq_u32 s6, 2
s_cbranch_scc1 L_tr_gu
s_cmp_eq_u32 s6, 3
s_cbranch_scc1 L_tr_dn
v_lshl_add_u32 v12, v13, 3, v12
s_lshl_b32 s68, s26, 5
v_add_u32 v12, s68, v12
s_branch L_tr_n
L_tr_gu:
v_and_b32 v14, 1, v13
v_lshl_add_u32 v12, v14, 3, v12
v_lshrrev_b32 v14, 1, v13
v_lshl_add_u32 v12, v14, 6, v12
s_lshl_b32 s68, s26, 4
v_add_u32 v12, s68, v12
L_tr_n:
ds_read_b64_tr_b16 v[88:89], v12 offset:0
ds_read_b64_tr_b16 v[90:91], v12 offset:512
ds_read_b64_tr_b16 v[92:93], v12 offset:4096
ds_read_b64_tr_b16 v[94:95], v12 offset:4608
ds_read_b64_tr_b16 v[96:97], v12 offset:8192
ds_read_b64_tr_b16 v[98:99], v12 offset:8704
ds_read_b64_tr_b16 v[100:101], v12 offset:12288
ds_read_b64_tr_b16 v[102:103], v12 offset:12800
s_waitcnt lgkmcnt(0)
ds_read_b64_tr_b16 v[104:105], v12 offset:16384
ds_read_b64_tr_b16 v[106:107], v12 offset:16896
ds_read_b64_tr_b16 v[108:109], v12 offset:20480
ds_read_b64_tr_b16 v[110:111], v12 offset:20992
ds_read_b64_tr_b16 v[112:113], v12 offset:24576
ds_read_b64_tr_b16 v[114:115], v12 offset:25088
ds_read_b64_tr_b16 v[116:117], v12 offset:28672
ds_read_b64_tr_b16 v[118:119], v12 offset:29184
s_waitcnt lgkmcnt(0)
ds_read_b64_tr_b16 v[120:121], v12 offset:32768
ds_read_b64_tr_b16 v[122:123], v12 offset:33280
ds_read_b64_tr_b16 v[124:125], v12 offset:36864
ds_read_b64_tr_b16 v[126:127], v12 offset:37376
ds_read_b64_tr_b16 v[128:129], v12 offset:40960
ds_read_b64_tr_b16 v[130:131], v12 offset:41472
ds_read_b64_tr_b16 v[132:133], v12 offset:45056
ds_read_b64_tr_b16 v[134:135], v12 offset:45568
s_waitcnt lgkmcnt(0)
ds_read_b64_tr_b16 v[136:137], v12 offset:49152
ds_read_b64_tr_b16 v[138:139], v12 offset:49664
ds_read_b64_tr_b16 v[140:141], v12 offset:53248
ds_read_b64_tr_b16 v[142:143], v12 offset:53760
s_branch L_tr_d
L_tr_dn:
v_lshl_add_u32 v12, v13, 3, v12
s_and_b32 s68, s26, 1
s_lshl_b32 s68, s68, 6
v_add_u32 v12, s68, v12
ds_read_b64_tr_b16 v[88:89], v12 offset:0
ds_read_b64_tr_b16 v[90:91], v12 offset:512
ds_read_b64_tr_b16 v[92:93], v12 offset:32
ds_read_b64_tr_b16 v[94:95], v12 offset:544
ds_read_b64_tr_b16 v[96:97], v12 offset:4096
ds_read_b64_tr_b16 v[98:99], v12 offset:4608
ds_read_b64_tr_b16 v[100:101], v12 offset:4128
ds_read_b64_tr_b16 v[102:103], v12 offset:4640
s_waitcnt lgkmcnt(0)
ds_read_b64_tr_b16 v[104:105], v12 offset:8192
ds_read_b64_tr_b16 v[106:107], v12 offset:8704
ds_read_b64_tr_b16 v[108:109], v12 offset:8224
ds_read_b64_tr_b16 v[110:111], v12 offset:8736
ds_read_b64_tr_b16 v[112:113], v12 offset:12288
ds_read_b64_tr_b16 v[114:115], v12 offset:12800
ds_read_b64_tr_b16 v[116:117], v12 offset:12320
ds_read_b64_tr_b16 v[118:119], v12 offset:12832
s_waitcnt lgkmcnt(0)
ds_read_b64_tr_b16 v[120:121], v12 offset:16384
ds_read_b64_tr_b16 v[122:123], v12 offset:16896
ds_read_b64_tr_b16 v[124:125], v12 offset:16416
ds_read_b64_tr_b16 v[126:127], v12 offset:16928
ds_read_b64_tr_b16 v[128:129], v12 offset:20480
ds_read_b64_tr_b16 v[130:131], v12 offset:20992
ds_read_b64_tr_b16 v[132:133], v12 offset:20512
ds_read_b64_tr_b16 v[134:135], v12 offset:21024
s_waitcnt lgkmcnt(0)
ds_read_b64_tr_b16 v[136:137], v12 offset:24576
ds_read_b64_tr_b16 v[138:139], v12 offset:25088
ds_read_b64_tr_b16 v[140:141], v12 offset:24608
ds_read_b64_tr_b16 v[142:143], v12 offset:25120
s_branch L_tr_d
L_tr_wo:
v_lshl_add_u32 v12, v13, 3, v12
v_add_u32 v12, s3, v12
ds_read_b64_tr_b16 v[88:89], v12 offset:0
ds_read_b64_tr_b16 v[90:91], v12 offset:512
ds_read_b64_tr_b16 v[92:93], v12 offset:32
ds_read_b64_tr_b16 v[94:95], v12 offset:544
ds_read_b64_tr_b16 v[96:97], v12 offset:64
ds_read_b64_tr_b16 v[98:99], v12 offset:576
ds_read_b64_tr_b16 v[100:101], v12 offset:96
ds_read_b64_tr_b16 v[102:103], v12 offset:608
s_waitcnt lgkmcnt(0)
ds_read_b64_tr_b16 v[104:105], v12 offset:4096
ds_read_b64_tr_b16 v[106:107], v12 offset:4608
ds_read_b64_tr_b16 v[108:109], v12 offset:4128
ds_read_b64_tr_b16 v[110:111], v12 offset:4640
ds_read_b64_tr_b16 v[112:113], v12 offset:4160
ds_read_b64_tr_b16 v[114:115], v12 offset:4672
ds_read_b64_tr_b16 v[116:117], v12 offset:4192
ds_read_b64_tr_b16 v[118:119], v12 offset:4704
s_waitcnt lgkmcnt(0)
ds_read_b64_tr_b16 v[120:121], v12 offset:8192
ds_read_b64_tr_b16 v[122:123], v12 offset:8704
ds_read_b64_tr_b16 v[124:125], v12 offset:8224
ds_read_b64_tr_b16 v[126:127], v12 offset:8736
ds_read_b64_tr_b16 v[128:129], v12 offset:8256
ds_read_b64_tr_b16 v[130:131], v12 offset:8768
ds_read_b64_tr_b16 v[132:133], v12 offset:8288
ds_read_b64_tr_b16 v[134:135], v12 offset:8800
s_waitcnt lgkmcnt(0)
ds_read_b64_tr_b16 v[136:137], v12 offset:12288
ds_read_b64_tr_b16 v[138:139], v12 offset:12800
ds_read_b64_tr_b16 v[140:141], v12 offset:12320
ds_read_b64_tr_b16 v[142:143], v12 offset:12832
ds_read_b64_tr_b16 v[144:145], v12 offset:12352
ds_read_b64_tr_b16 v[146:147], v12 offset:12864
ds_read_b64_tr_b16 v[148:149], v12 offset:12384
ds_read_b64_tr_b16 v[150:151], v12 offset:12896
s_waitcnt lgkmcnt(0)
L_tr_d:
s_waitcnt lgkmcnt(0)
s_add_u32 s46, s46, 0x9e3779b9
s_barrier
s_cmp_eq_u32 s101, 1
s_cbranch_scc1 KG_5
s_add_u32 s68, s35, 786432
buffer_load_dwordx4 a[96:99], v22, s[8:11], s68 offen offset:0 nt
buffer_load_dwordx4 a[100:103], v22, s[8:11], s68 offen offset:256 nt
buffer_load_dwordx4 a[104:107], v22, s[8:11], s68 offen offset:512 nt
buffer_load_dwordx4 a[108:111], v22, s[8:11], s68 offen offset:768 nt
buffer_load_dwordx4 a[112:115], v22, s[8:11], s68 offen offset:1024 nt
buffer_load_dwordx4 a[116:119], v22, s[8:11], s68 offen offset:1280 nt
buffer_load_dwordx4 a[120:123], v22, s[8:11], s68 offen offset:1536 nt
buffer_load_dwordx4 a[124:127], v22, s[8:11], s68 offen offset:1792 nt
s_branch KD_6
KG_5:
s_add_u32 s68, s35, 1572864
buffer_load_dwordx4 a[192:195], v22, s[8:11], s68 offen offset:0 nt
buffer_load_dwordx4 a[196:199], v22, s[8:11], s68 offen offset:256 nt
buffer_load_dwordx4 a[200:203], v22, s[8:11], s68 offen offset:512 nt
buffer_load_dwordx4 a[204:207], v22, s[8:11], s68 offen offset:768 nt
buffer_load_dwordx4 a[208:211], v22, s[8:11], s68 offen offset:1024 nt
buffer_load_dwordx4 a[212:215], v22, s[8:11], s68 offen offset:1280 nt
buffer_load_dwordx4 a[216:219], v22, s[8:11], s68 offen offset:1536 nt
buffer_load_dwordx4 a[220:223], v22, s[8:11], s68 offen offset:1792 nt
KD_6:
s_cmp_eq_u32 s6, 2
s_cbranch_scc0 L_nocs
v_mov_b32 v8, 0x3f803f80
v_mov_b32 v9, 0x3f803f80
v_mov_b32 v10, 0x3f803f80
v_mov_b32 v11, 0x3f803f80
s_nop 1
v_mfma_f32_16x16x32_bf16 v[4:7], v[8:11], v[88:91], 0
v_mfma_f32_16x16x32_bf16 v[4:7], v[8:11], v[92:95], v[4:7]
v_mfma_f32_16x16x32_bf16 v[4:7], v[8:11], v[96:99], v[4:7]
v_mfma_f32_16x16x32_bf16 v[4:7], v[8:11], v[100:103], v[4:7]
v_mfma_f32_16x16x32_bf16 v[4:7], v[8:11], v[104:107], v[4:7]
v_mfma_f32_16x16x32_bf16 v[4:7], v[8:11], v[108:111], v[4:7]
v_mfma_f32_16x16x32_bf16 v[4:7], v[8:11], v[112:115], v[4:7]
v_mfma_f32_16x16x32_bf16 v[4:7], v[8:11], v[116:119], v[4:7]
v_mfma_f32_16x16x32_bf16 v[4:7], v[8:11], v[120:123], v[4:7]
v_mfma_f32_16x16x32_bf16 v[4:7], v[8:11], v[124:127], v[4:7]
v_mfma_f32_16x16x32_bf16 v[4:7], v[8:11], v[128:131], v[4:7]
v_mfma_f32_16x16x32_bf16 v[4:7], v[8:11], v[132:135], v[4:7]
v_mfma_f32_16x16x32_bf16 v[4:7], v[8:11], v[136:139], v[4:7]
v_mfma_f32_16x16x32_bf16 v[4:7], v[8:11], v[140:143], v[4:7]
s_nop 7
v_mov_b32 v1, v4
L_nocs:
s_cmp_eq_u32 s6, 0
s_cbranch_scc0 L_noeq
v_and_b32 v12, 1, v0
v_mul_u32_u24 v12, 896, v12
v_lshrrev_b32 v3, 4, v0
v_lshl_add_u32 v12, v3, 4, v12
v_add_u32 v12, 160384, v12
v_mov_b32 v80, 0
v_mov_b32 v81, 0
v_mov_b32 v82, 0
v_mov_b32 v83, 0
v_mov_b32 v84, 0
v_mov_b32 v85, 0
v_mov_b32 v86, 0
v_mov_b32 v87, 0
v_add_u32 v13, 160384, v2
s_mov_b32 exec_lo, 0xffffffff
s_mov_b32 exec_hi, 0xffffff
ds_read_b128 v[80:83], v13
ds_read_b128 v[84:87], v13 offset:896
s_mov_b64 exec, -1
ds_read_b128 v[24:27], v12 offset:0
ds_read_b128 v[28:31], v12 offset:64
ds_read_b128 v[32:35], v12 offset:128
ds_read_b128 v[36:39], v12 offset:192
ds_read_b128 v[40:43], v12 offset:256
ds_read_b128 v[44:47], v12 offset:320
ds_read_b128 v[48:51], v12 offset:384
ds_read_b128 v[52:55], v12 offset:448
ds_read_b128 v[56:59], v12 offset:512
ds_read_b128 v[60:63], v12 offset:576
ds_read_b128 v[64:67], v12 offset:640
ds_read_b128 v[68:71], v12 offset:704
s_waitcnt lgkmcnt(8)
ds_read_b128 v[72:75], v12 offset:768
ds_read_b128 v[76:79], v12 offset:832
v_mov_b32 v8, 0x3f803f80
v_mov_b32 v9, 0x3f803f80
v_mov_b32 v10, 0x3f803f80
v_mov_b32 v11, 0x3f803f80
s_nop 1
v_mfma_f32_16x16x32_bf16 v[4:7], v[8:11], v[88:91], 0
v_mfma_f32_16x16x32_bf16 v[4:7], v[8:11], v[92:95], v[4:7]
v_mfma_f32_16x16x32_bf16 v[4:7], v[8:11], v[96:99], v[4:7]
v_mfma_f32_16x16x32_bf16 v[4:7], v[8:11], v[100:103], v[4:7]
v_mfma_f32_16x16x32_bf16 v[4:7], v[8:11], v[104:107], v[4:7]
v_mfma_f32_16x16x32_bf16 v[4:7], v[8:11], v[108:111], v[4:7]
v_mfma_f32_16x16x32_bf16 v[4:7], v[8:11], v[112:115], v[4:7]
v_mfma_f32_16x16x32_bf16 v[4:7], v[8:11], v[116:119], v[4:7]
v_mfma_f32_16x16x32_bf16 v[4:7], v[8:11], v[120:123], v[4:7]
v_mfma_f32_16x16x32_bf16 v[4:7], v[8:11], v[124:127], v[4:7]
v_mfma_f32_16x16x32_bf16 v[4:7], v[8:11], v[128:131], v[4:7]
v_mfma_f32_16x16x32_bf16 v[4:7], v[8:11], v[132:135], v[4:7]
v_mfma_f32_16x16x32_bf16 v[4:7], v[8:11], v[136:139], v[4:7]
v_mfma_f32_16x16x32_bf16 v[4:7], v[8:11], v[140:143], v[4:7]
s_nop 7
v_mov_b32 v1, v4
s_waitcnt lgkmcnt(0)
v_mov_b32 v16, 0
v_mov_b32 v17, 0
v_lshlrev_b32 v12, 16, v80
v_and_b32 v13, 0xffff0000, v80
v_add_f32 v16, v16, v12
v_fmac_f32 v17, v12, v12
v_add_f32 v16, v16, v13
v_fmac_f32 v17, v13, v13
v_lshlrev_b32 v12, 16, v81
v_and_b32 v13, 0xffff0000, v81
v_add_f32 v16, v16, v12
v_fmac_f32 v17, v12, v12
v_add_f32 v16, v16, v13
v_fmac_f32 v17, v13, v13
v_lshlrev_b32 v12, 16, v82
v_and_b32 v13, 0xffff0000, v82
v_add_f32 v16, v16, v12
v_fmac_f32 v17, v12, v12
v_add_f32 v16, v16, v13
v_fmac_f32 v17, v13, v13
v_lshlrev_b32 v12, 16, v83
v_and_b32 v13, 0xffff0000, v83
v_add_f32 v16, v16, v12
v_fmac_f32 v17, v12, v12
v_add_f32 v16, v16, v13
v_fmac_f32 v17, v13, v13
v_mov_b32 v18, 0
v_mov_b32 v19, 0
v_lshlrev_b32 v12, 16, v84
v_and_b32 v13, 0xffff0000, v84
v_add_f32 v18, v18, v12
v_fmac_f32 v19, v12, v12
v_add_f32 v18, v18, v13
v_fmac_f32 v19, v13, v13
v_lshlrev_b32 v12, 16, v85
v_and_b32 v13, 0xffff0000, v85
v_add_f32 v18, v18, v12
v_fmac_f32 v19, v12, v12
v_add_f32 v18, v18, v13
v_fmac_f32 v19, v13, v13
v_lshlrev_b32 v12, 16, v86
v_and_b32 v13, 0xffff0000, v86
v_add_f32 v18, v18, v12
v_fmac_f32 v19, v12, v12
v_add_f32 v18, v18, v13
v_fmac_f32 v19, v13, v13
v_lshlrev_b32 v12, 16, v87
v_and_b32 v13, 0xffff0000, v87
v_add_f32 v18, v18, v12
v_fmac_f32 v19, v12, v12
v_add_f32 v18, v18, v13
v_fmac_f32 v19, v13, v13
v_add_f32_dpp v16, v16, v16 row_ror:8 row_mask:0xf bank_mask:0xf
v_add_f32_dpp v17, v17, v17 row_ror:8 row_mask:0xf bank_mask:0xf
v_add_f32_dpp v18, v18, v18 row_ror:8 row_mask:0xf bank_mask:0xf
v_add_f32_dpp v19, v19, v19 row_ror:8 row_mask:0xf bank_mask:0xf
v_add_f32_dpp v16, v16, v16 row_ror:4 row_mask:0xf bank_mask:0xf
v_add_f32_dpp v17, v17, v17 row_ror:4 row_mask:0xf bank_mask:0xf
v_add_f32_dpp v18, v18, v18 row_ror:4 row_mask:0xf bank_mask:0xf
v_add_f32_dpp v19, v19, v19 row_ror:4 row_mask:0xf bank_mask:0xf
v_add_f32_dpp v16, v16, v16 row_ror:2 row_mask:0xf bank_mask:0xf
v_add_f32_dpp v17, v17, v17 row_ror:2 row_mask:0xf bank_mask:0xf
v_add_f32_dpp v18, v18, v18 row_ror:2 row_mask:0xf bank_mask:0xf
v_add_f32_dpp v19, v19, v19 row_ror:2 row_mask:0xf bank_mask:0xf
v_add_f32_dpp v16, v16, v16 row_ror:1 row_mask:0xf bank_mask:0xf
v_add_f32_dpp v17, v17, v17 row_ror:1 row_mask:0xf bank_mask:0xf
v_add_f32_dpp v18, v18, v18 row_ror:1 row_mask:0xf bank_mask:0xf
v_add_f32_dpp v19, v19, v19 row_ror:1 row_mask:0xf bank_mask:0xf
v_mov_b32 v12, v16
s_nop 1
v_permlane16_swap_b32 v16, v12
v_add_f32 v16, v16, v12
v_mov_b32 v12, v17
s_nop 1
v_permlane16_swap_b32 v17, v12
v_add_f32 v17, v17, v12
v_mov_b32 v12, v18
s_nop 1
v_permlane16_swap_b32 v18, v12
v_add_f32 v18, v18, v12
v_mov_b32 v12, v19
s_nop 1
v_permlane16_swap_b32 v19, v12
v_add_f32 v19, v19, v12
v_mov_b32 v12, v16
s_nop 1
v_permlane32_swap_b32 v16, v12
v_add_f32 v16, v16, v12
v_mov_b32 v12, v17
s_nop 1
v_permlane32_swap_b32 v17, v12
v_add_f32 v17, v17, v12
v_mov_b32 v12, v18
s_nop 1
v_permlane32_swap_b32 v18, v12
v_add_f32 v18, v18, v12
v_mov_b32 v12, v19
s_nop 1
v_permlane32_swap_b32 v19, v12
v_add_f32 v19, v19, v12
v_cndmask_b32 v16, v16, v18, s[60:61]
v_cndmask_b32 v17, v17, v19, s[60:61]
v_mul_f32 v16, 0x3b124925, v16
v_mul_f32 v17, 0x3b124925, v17
v_fma_f32 v17, -v16, v16, v17
v_max_f32 v17, 0, v17
v_add_f32 v17, 0x3727c5ac, v17
v_rsq_f32 v17, v17
s_nop 0
v_mul_f32 v17, 0x3db8aa3b, v17
L_noeq:
s_cmp_eq_u32 s101, 1
s_cbranch_scc1 KG_7
s_add_u32 s68, s35, 1048576
buffer_load_dwordx4 a[128:131], v22, s[8:11], s68 offen offset:0 nt
buffer_load_dwordx4 a[132:135], v22, s[8:11], s68 offen offset:256 nt
buffer_load_dwordx4 a[136:139], v22, s[8:11], s68 offen offset:512 nt
buffer_load_dwordx4 a[140:143], v22, s[8:11], s68 offen offset:768 nt
buffer_load_dwordx4 a[144:147], v22, s[8:11], s68 offen offset:1024 nt
buffer_load_dwordx4 a[148:151], v22, s[8:11], s68 offen offset:1280 nt
buffer_load_dwordx4 a[152:155], v22, s[8:11], s68 offen offset:1536 nt
buffer_load_dwordx4 a[156:159], v22, s[8:11], s68 offen offset:1792 nt
s_branch KD_8
KG_7:
s_add_u32 s68, s35, 1835008
buffer_load_dwordx4 a[224:227], v22, s[8:11], s68 offen offset:0 nt
buffer_load_dwordx4 a[228:231], v22, s[8:11], s68 offen offset:256 nt
buffer_load_dwordx4 a[232:235], v22, s[8:11], s68 offen offset:512 nt
buffer_load_dwordx4 a[236:239], v22, s[8:11], s68 offen offset:768 nt
buffer_load_dwordx4 a[240:243], v22, s[8:11], s68 offen offset:1024 nt
buffer_load_dwordx4 a[244:247], v22, s[8:11], s68 offen offset:1280 nt
buffer_load_dwordx4 a[248:251], v22, s[8:11], s68 offen offset:1536 nt
buffer_load_dwordx4 a[252:255], v22, s[8:11], s68 offen offset:1792 nt
KD_8:
s_cmp_eq_u32 s6, 0
s_cbranch_scc0 L_noeq2
v_mfma_f32_16x16x32_bf16 v[4:7], v[24:27], v[88:91], 0
v_mfma_f32_16x16x32_bf16 v[4:7], v[28:31], v[92:95], v[4:7]
v_mfma_f32_16x16x32_bf16 v[4:7], v[32:35], v[96:99], v[4:7]
v_mfma_f32_16x16x32_bf16 v[4:7], v[36:39], v[100:103], v[4:7]
v_mfma_f32_16x16x32_bf16 v[4:7], v[40:43], v[104:107], v[4:7]
v_mfma_f32_16x16x32_bf16 v[4:7], v[44:47], v[108:111], v[4:7]
v_mfma_f32_16x16x32_bf16 v[4:7], v[48:51], v[112:115], v[4:7]
v_mfma_f32_16x16x32_bf16 v[4:7], v[52:55], v[116:119], v[4:7]
v_mfma_f32_16x16x32_bf16 v[4:7], v[56:59], v[120:123], v[4:7]
v_mfma_f32_16x16x32_bf16 v[4:7], v[60:63], v[124:127], v[4:7]
v_mfma_f32_16x16x32_bf16 v[4:7], v[64:67], v[128:131], v[4:7]
v_mfma_f32_16x16x32_bf16 v[4:7], v[68:71], v[132:135], v[4:7]
v_mfma_f32_16x16x32_bf16 v[4:7], v[72:75], v[136:139], v[4:7]
v_mfma_f32_16x16x32_bf16 v[4:7], v[76:79], v[140:143], v[4:7]
s_nop 7
v_permlane16_swap_b32 v4, v5
v_fma_f32 v8, -v16, v1, v4
v_mul_f32 v8, v8, v17
s_nop 1
v_mov_b32_dpp v10, v8 quad_perm:[1,0,3,2] row_mask:0xf bank_mask:0xf
v_cvt_pk_bf16_f32 v8, v8, v10
v_mov_b32 v9, s46
v_bfe_u32 v11, v0, 4, 1
v_lshlrev_b32 v11, 11, v11
v_and_b32 v12, 15, v0
v_lshl_add_u32 v11, v12, 2, v11
s_lshl_b32 s68, s7, 6
v_add_u32 v11, s68, v11
s_lshl_b32 s68, s27, 12
s_add_u32 s68, s68, 1015808
s_add_u32 s70, s20, s68
s_addc_u32 s71, s21, 0
s_mov_b32 exec_lo, 0x55555555
s_mov_b32 exec_hi, 0x0
global_store_dwordx2 v11, v[8:9], s[70:71] sc1
s_mov_b64 exec, -1
L_noeq2:
s_cmp_eq_u32 s101, 1
s_cbranch_scc1 KG_9
s_add_u32 s68, s35, 1310720
s_waitcnt vmcnt(8)
buffer_load_dwordx4 a[160:163], v22, s[8:11], s68 offen offset:0 nt
buffer_load_dwordx4 a[164:167], v22, s[8:11], s68 offen offset:256 nt
buffer_load_dwordx4 a[168:171], v22, s[8:11], s68 offen offset:512 nt
buffer_load_dwordx4 a[172:175], v22, s[8:11], s68 offen offset:768 nt
s_waitcnt vmcnt(8)
buffer_load_dwordx4 a[176:179], v22, s[8:11], s68 offen offset:1024 nt
buffer_load_dwordx4 a[180:183], v22, s[8:11], s68 offen offset:1280 nt
buffer_load_dwordx4 a[184:187], v22, s[8:11], s68 offen offset:1536 nt
buffer_load_dwordx4 a[188:191], v22, s[8:11], s68 offen offset:1792 nt
s_branch KD_10
KG_9:
KD_10:
s_cmp_eq_u32 s101, 1
s_cbranch_scc1 KG_11
s_add_u32 s68, s35, 1572864
s_waitcnt vmcnt(8)
buffer_load_dwordx4 a[192:195], v22, s[8:11], s68 offen offset:0 nt
buffer_load_dwordx4 a[196:199], v22, s[8:11], s68 offen offset:256 nt
buffer_load_dwordx4 a[200:203], v22, s[8:11], s68 offen offset:512 nt
buffer_load_dwordx4 a[204:207], v22, s[8:11], s68 offen offset:768 nt
s_waitcnt vmcnt(8)
buffer_load_dwordx4 a[208:211], v22, s[8:11], s68 offen offset:1024 nt
buffer_load_dwordx4 a[212:215], v22, s[8:11], s68 offen offset:1280 nt
buffer_load_dwordx4 a[216:219], v22, s[8:11], s68 offen offset:1536 nt
buffer_load_dwordx4 a[220:223], v22, s[8:11], s68 offen offset:1792 nt
s_branch KD_12
KG_11:
KD_12:
s_cmp_eq_u32 s101, 1
s_cbranch_scc1 KG_13
s_add_u32 s68, s35, 1835008
s_waitcnt vmcnt(8)
buffer_load_dwordx4 a[224:227], v22, s[8:11], s68 offen offset:0 nt
buffer_load_dwordx4 a[228:231], v22, s[8:11], s68 offen offset:256 nt
buffer_load_dwordx4 a[232:235], v22, s[8:11], s68 offen offset:512 nt
buffer_load_dwordx4 a[236:239], v22, s[8:11], s68 offen offset:768 nt
s_waitcnt vmcnt(8)
buffer_load_dwordx4 a[240:243], v22, s[8:11], s68 offen offset:1024 nt
buffer_load_dwordx4 a[244:247], v22, s[8:11], s68 offen offset:1280 nt
buffer_load_dwordx4 a[248:251], v22, s[8:11], s68 offen offset:1536 nt
buffer_load_dwordx4 a[252:255], v22, s[8:11], s68 offen offset:1792 nt
s_branch KD_14
KG_13:
KD_14:
s_lshl_b32 s68, s27, 12
s_add_u32 s68, s68, 1015808
s_add_u32 s70, s20, s68
s_addc_u32 s71, s21, 0
s_lshl_b32 s68, s30, 11
s_lshl_b32 s78, s29, 10
s_add_u32 s68, s68, s78
v_add_u32 v18, s68, v2
global_load_dwordx4 v[14:17], v18, s[70:71] sc1
s_add_u32 s68, s35, 0
s_add_u32 m0, s3, 0
s_nop 0
buffer_load_dwordx4 v23, s[12:15], s68 offen offset:0 nt lds
s_add_u32 m0, s3, 768
s_nop 0
buffer_load_dwordx4 v23, s[12:15], s68 offen offset:256 nt lds
s_add_u32 m0, s3, 1536
s_nop 0
buffer_load_dwordx4 v23, s[12:15], s68 offen offset:512 nt lds
s_add_u32 m0, s3, 2304
s_nop 0
buffer_load_dwordx4 v23, s[12:15], s68 offen offset:768 nt lds
s_add_u32 m0, s3, 3072
s_nop 0
buffer_load_dwordx4 v23, s[12:15], s68 offen offset:1024 nt lds
s_add_u32 m0, s3, 3840
s_nop 0
buffer_load_dwordx4 v23, s[12:15], s68 offen offset:1280 nt lds
s_add_u32 m0, s3, 4608
s_nop 0
buffer_load_dwordx4 v23, s[12:15], s68 offen offset:1536 nt lds
s_add_u32 m0, s3, 5376
s_nop 0
buffer_load_dwordx4 v23, s[12:15], s68 offen offset:1792 nt lds
s_add_u32 s68, s35, 262144
s_add_u32 m0, s3, 8192
s_nop 0
buffer_load_dwordx4 v23, s[12:15], s68 offen offset:0 nt lds
s_add_u32 m0, s3, 8960
s_nop 0
buffer_load_dwordx4 v23, s[12:15], s68 offen offset:256 nt lds
s_add_u32 m0, s3, 9728
s_nop 0
buffer_load_dwordx4 v23, s[12:15], s68 offen offset:512 nt lds
s_add_u32 m0, s3, 10496
s_nop 0
buffer_load_dwordx4 v23, s[12:15], s68 offen offset:768 nt lds
s_add_u32 m0, s3, 11264
s_nop 0
buffer_load_dwordx4 v23, s[12:15], s68 offen offset:1024 nt lds
s_add_u32 m0, s3, 12032
s_nop 0
buffer_load_dwordx4 v23, s[12:15], s68 offen offset:1280 nt lds
s_add_u32 m0, s3, 12800
s_nop 0
buffer_load_dwordx4 v23, s[12:15], s68 offen offset:1536 nt lds
s_add_u32 m0, s3, 13568
s_nop 0
buffer_load_dwordx4 v23, s[12:15], s68 offen offset:1792 nt lds
s_add_u32 s68, s35, 524288
s_add_u32 m0, s3, 16384
s_nop 0
buffer_load_dwordx4 v23, s[12:15], s68 offen offset:0 nt lds
s_add_u32 m0, s3, 17152
s_nop 0
buffer_load_dwordx4 v23, s[12:15], s68 offen offset:256 nt lds
s_add_u32 m0, s3, 17920
s_nop 0
buffer_load_dwordx4 v23, s[12:15], s68 offen offset:512 nt lds
s_add_u32 m0, s3, 18688
s_nop 0
buffer_load_dwordx4 v23, s[12:15], s68 offen offset:768 nt lds
s_add_u32 m0, s3, 19456
s_nop 0
buffer_load_dwordx4 v23, s[12:15], s68 offen offset:1024 nt lds
s_add_u32 m0, s3, 20224
s_nop 0
buffer_load_dwordx4 v23, s[12:15], s68 offen offset:1280 nt lds
s_add_u32 m0, s3, 20992
s_nop 0
buffer_load_dwordx4 v23, s[12:15], s68 offen offset:1536 nt lds
s_add_u32 m0, s3, 21760
s_nop 0
buffer_load_dwordx4 v23, s[12:15], s68 offen offset:1792 nt lds
L_layer:
v_and_b32 v3, 1, v0
v_lshlrev_b32 v3, 4, v3
v_mov_b32 v13, 0xffff
v_lshlrev_b32 v13, v3, v13
v_cndmask_b32 v20, 0, v13, s[54:55]
v_cndmask_b32 v21, 0, v13, s[56:57]
v_cndmask_b32 v22, 0, v13, s[58:59]
v_cndmask_b32 v23, 0, v13, s[62:63]
v_lshrrev_b32 v12, 4, v0
v_lshlrev_b32 v12, 11, v12
v_and_b32 v3, 15, v0
v_lshl_add_u32 v12, v3, 4, v12
v_mov_b32 v40, 0
v_mov_b32 v41, 0
v_mov_b32 v42, 0
v_mov_b32 v43, 0
v_mov_b32 v44, 0
v_mov_b32 v45, 0
v_mov_b32 v46, 0
v_mov_b32 v47, 0
v_mov_b32 v48, 0
v_mov_b32 v49, 0
v_mov_b32 v50, 0
v_mov_b32 v51, 0
v_mov_b32 v52, 0
v_mov_b32 v53, 0
v_mov_b32 v54, 0
v_mov_b32 v55, 0
v_lshrrev_b32 v86, 4, v0
v_lshlrev_b32 v86, 6, v86
v_and_b32 v3, 3, v0
v_lshl_add_u32 v86, v3, 4, v86
v_add_u32 v86, 159808, v86
s_cmp_eq_u32 s34, 0
s_cbranch_scc0 L_q1
s_waitcnt vmcnt(24)
L_q0:
v_xor_b32 v19, s46, v15
v_xor_b32 v13, s46, v17
v_or_b32 v19, v19, v13
v_cmp_ne_u32 vcc, 0, v19
s_cbranch_vccz L_q0_d
s_cmp_eq_u32 s33, 0
s_cbranch_scc1 L_q0_d
s_sub_u32 s33, s33, 1
global_load_dwordx4 v[14:17], v18, s[70:71] sc1
s_waitcnt vmcnt(0)
s_branch L_q0
L_q0_d:
v_mov_b32 v15, v16
v_lshlrev_b32 v13, 3, v0
v_add_u32 v13, 159808, v13
ds_write_b64 v13, v[14:15]
s_waitcnt lgkmcnt(0)
s_branch L_qlds
L_q1:
s_cmp_eq_u32 s26, 0
s_cbranch_scc0 L_q1b
s_add_u32 s70, s22, 32768
s_addc_u32 s71, s23, 0
s_lshl_b32 s68, s30, 10
s_lshl_b32 s78, s29, 9
s_add_u32 s68, s68, s78
v_add_u32 v13, s68, v2
v_add_u32 v18, 159808, v2
s_mov_b32 exec_lo, 0xffffffff
s_mov_b32 exec_hi, 0x0
global_load_dwordx4 v[56:59], v13, s[70:71] sc1
L_q1p:
global_load_dwordx4 v[60:63], v13, s[70:71] sc1
s_waitcnt vmcnt(1)
v_max3_u32 v19, v56, v57, v58
v_max_u32 v19, v19, v59
v_cmp_eq_u32 vcc, -1, v19
s_cbranch_vccz L_q1_ok0
global_load_dwordx4 v[56:59], v13, s[70:71] sc1
s_waitcnt vmcnt(1)
v_max3_u32 v19, v60, v61, v62
v_max_u32 v19, v19, v63
v_cmp_eq_u32 vcc, -1, v19
s_cbranch_vccz L_q1_ok1
s_cmp_eq_u32 s33, 0
s_cbranch_scc1 L_q1_ok0
s_sub_u32 s33, s33, 1
s_sleep 1
s_branch L_q1p
L_q1_ok1:
ds_write_b128 v18, v[60:63]
s_branch L_q1_w
L_q1_ok0:
ds_write_b128 v18, v[56:59]
L_q1_w:
s_mov_b64 exec, -1
s_waitcnt lgkmcnt(0)
L_q1b:
s_barrier
L_qlds:
s_mov_b32 exec_lo, 0xff00ff
s_mov_b32 exec_hi, 0xff00ff
ds_read_b128 v[40:43], v86 offset:0
ds_read_b128 v[44:47], v86 offset:256
s_mov_b32 exec_lo, 0xff00ff00
s_mov_b32 exec_hi, 0xff00ff00
ds_read_b128 v[48:51], v86 offset:0
ds_read_b128 v[52:55], v86 offset:256
s_mov_b64 exec, -1
v_add_u32 v17, s3, v2
s_waitcnt vmcnt(24)
s_waitcnt lgkmcnt(0)
v_mfma_f32_16x16x32_bf16 v[64:67], a[0:3], v[40:43], 0
v_mfma_f32_16x16x32_bf16 v[64:67], a[4:7], v[44:47], v[64:67]
v_mfma_f32_16x16x32_bf16 v[64:67], a[8:11], v[48:51], v[64:67]
v_mfma_f32_16x16x32_bf16 v[64:67], a[12:15], v[52:55], v[64:67]
v_mfma_f32_16x16x32_bf16 v[68:71], a[16:19], v[40:43], 0
v_mfma_f32_16x16x32_bf16 v[68:71], a[20:23], v[44:47], v[68:71]
v_mfma_f32_16x16x32_bf16 v[68:71], a[24:27], v[48:51], v[68:71]
v_mfma_f32_16x16x32_bf16 v[68:71], a[28:31], v[52:55], v[68:71]
v_mfma_f32_16x16x32_bf16 v[72:75], a[32:35], v[40:43], 0
s_nop 2
v_cndmask_b32 v24, v64, v65, s[48:49]
v_mfma_f32_16x16x32_bf16 v[72:75], a[36:39], v[44:47], v[72:75]
v_cndmask_b32 v24, v24, v66, s[50:51]
v_mfma_f32_16x16x32_bf16 v[72:75], a[40:43], v[48:51], v[72:75]
v_cndmask_b32 v24, v24, v67, s[52:53]
v_mfma_f32_16x16x32_bf16 v[72:75], a[44:47], v[52:55], v[72:75]
v_mfma_f32_16x16x32_bf16 v[76:79], a[48:51], v[40:43], 0
v_cndmask_b32 v25, v68, v69, s[48:49]
v_add_f32_dpp v24, v24, v24 quad_perm:[1,0,3,2] row_mask:0xf bank_mask:0xf
v_mfma_f32_16x16x32_bf16 v[76:79], a[52:55], v[44:47], v[76:79]
v_cndmask_b32 v25, v25, v70, s[50:51]
v_mfma_f32_16x16x32_bf16 v[76:79], a[56:59], v[48:51], v[76:79]
v_cndmask_b32 v25, v25, v71, s[52:53]
v_add_f32_dpp v24, v24, v24 quad_perm:[2,3,0,1] row_mask:0xf bank_mask:0xf
v_mfma_f32_16x16x32_bf16 v[76:79], a[60:63], v[52:55], v[76:79]
v_mfma_f32_16x16x32_bf16 v[64:67], a[64:67], v[40:43], 0
v_cndmask_b32 v26, v72, v73, s[48:49]
v_add_f32_dpp v25, v25, v25 quad_perm:[1,0,3,2] row_mask:0xf bank_mask:0xf
v_mfma_f32_16x16x32_bf16 v[64:67], a[68:71], v[44:47], v[64:67]
v_cndmask_b32 v26, v26, v74, s[50:51]
v_mfma_f32_16x16x32_bf16 v[64:67], a[72:75], v[48:51], v[64:67]
v_cndmask_b32 v26, v26, v75, s[52:53]
v_add_f32_dpp v25, v25, v25 quad_perm:[2,3,0,1] row_mask:0xf bank_mask:0xf
v_mfma_f32_16x16x32_bf16 v[64:67], a[76:79], v[52:55], v[64:67]
v_mfma_f32_16x16x32_bf16 v[68:71], a[80:83], v[40:43], 0
v_cndmask_b32 v27, v76, v77, s[48:49]
v_add_f32_dpp v26, v26, v26 quad_perm:[1,0,3,2] row_mask:0xf bank_mask:0xf
v_mfma_f32_16x16x32_bf16 v[68:71], a[84:87], v[44:47], v[68:71]
v_cndmask_b32 v27, v27, v78, s[50:51]
v_mfma_f32_16x16x32_bf16 v[68:71], a[88:91], v[48:51], v[68:71]
v_cndmask_b32 v27, v27, v79, s[52:53]
v_add_f32_dpp v26, v26, v26 quad_perm:[2,3,0,1] row_mask:0xf bank_mask:0xf
v_mfma_f32_16x16x32_bf16 v[68:71], a[92:95], v[52:55], v[68:71]
v_max_f32 v18, v24, v25
v_mfma_f32_16x16x32_bf16 v[72:75], a[96:99], v[40:43], 0
v_cndmask_b32 v28, v64, v65, s[48:49]
v_add_f32_dpp v27, v27, v27 quad_perm:[1,0,3,2] row_mask:0xf bank_mask:0xf
v_mfma_f32_16x16x32_bf16 v[72:75], a[100:103], v[44:47], v[72:75]
v_cndmask_b32 v28, v28, v66, s[50:51]
v_mfma_f32_16x16x32_bf16 v[72:75], a[104:107], v[48:51], v[72:75]
v_cndmask_b32 v28, v28, v67, s[52:53]
v_add_f32_dpp v27, v27, v27 quad_perm:[2,3,0,1] row_mask:0xf bank_mask:0xf
v_mfma_f32_16x16x32_bf16 v[72:75], a[108:111], v[52:55], v[72:75]
v_mfma_f32_16x16x32_bf16 v[76:79], a[112:115], v[40:43], 0
v_cndmask_b32 v29, v68, v69, s[48:49]
v_add_f32_dpp v28, v28, v28 quad_perm:[1,0,3,2] row_mask:0xf bank_mask:0xf
v_mfma_f32_16x16x32_bf16 v[76:79], a[116:119], v[44:47], v[76:79]
v_cndmask_b32 v29, v29, v70, s[50:51]
v_mfma_f32_16x16x32_bf16 v[76:79], a[120:123], v[48:51], v[76:79]
v_cndmask_b32 v29, v29, v71, s[52:53]
v_add_f32_dpp v28, v28, v28 quad_perm:[2,3,0,1] row_mask:0xf bank_mask:0xf
v_mfma_f32_16x16x32_bf16 v[76:79], a[124:127], v[52:55], v[76:79]
v_max3_f32 v18, v18, v26, v27
v_mfma_f32_16x16x32_bf16 v[64:67], a[128:131], v[40:43], 0
v_cndmask_b32 v30, v72, v73, s[48:49]
v_add_f32_dpp v29, v29, v29 quad_perm:[1,0,3,2] row_mask:0xf bank_mask:0xf
v_mfma_f32_16x16x32_bf16 v[64:67], a[132:135], v[44:47], v[64:67]
v_cndmask_b32 v30, v30, v74, s[50:51]
v_mfma_f32_16x16x32_bf16 v[64:67], a[136:139], v[48:51], v[64:67]
v_cndmask_b32 v30, v30, v75, s[52:53]
v_add_f32_dpp v29, v29, v29 quad_perm:[2,3,0,1] row_mask:0xf bank_mask:0xf
v_mfma_f32_16x16x32_bf16 v[64:67], a[140:143], v[52:55], v[64:67]
v_mfma_f32_16x16x32_bf16 v[68:71], a[144:147], v[40:43], 0
v_cndmask_b32 v31, v76, v77, s[48:49]
v_add_f32_dpp v30, v30, v30 quad_perm:[1,0,3,2] row_mask:0xf bank_mask:0xf
v_mfma_f32_16x16x32_bf16 v[68:71], a[148:151], v[44:47], v[68:71]
v_cndmask_b32 v31, v31, v78, s[50:51]
v_mfma_f32_16x16x32_bf16 v[68:71], a[152:155], v[48:51], v[68:71]
v_cndmask_b32 v31, v31, v79, s[52:53]
v_add_f32_dpp v30, v30, v30 quad_perm:[2,3,0,1] row_mask:0xf bank_mask:0xf
v_mfma_f32_16x16x32_bf16 v[68:71], a[156:159], v[52:55], v[68:71]
v_max3_f32 v18, v18, v28, v29
v_mfma_f32_16x16x32_bf16 v[72:75], a[160:163], v[40:43], 0
v_cndmask_b32 v32, v64, v65, s[48:49]
v_add_f32_dpp v31, v31, v31 quad_perm:[1,0,3,2] row_mask:0xf bank_mask:0xf
v_mfma_f32_16x16x32_bf16 v[72:75], a[164:167], v[44:47], v[72:75]
v_cndmask_b32 v32, v32, v66, s[50:51]
v_mfma_f32_16x16x32_bf16 v[72:75], a[168:171], v[48:51], v[72:75]
v_cndmask_b32 v32, v32, v67, s[52:53]
v_add_f32_dpp v31, v31, v31 quad_perm:[2,3,0,1] row_mask:0xf bank_mask:0xf
v_mfma_f32_16x16x32_bf16 v[72:75], a[172:175], v[52:55], v[72:75]
v_mfma_f32_16x16x32_bf16 v[76:79], a[176:179], v[40:43], 0
v_cndmask_b32 v33, v68, v69, s[48:49]
v_add_f32_dpp v32, v32, v32 quad_perm:[1,0,3,2] row_mask:0xf bank_mask:0xf
v_mfma_f32_16x16x32_bf16 v[76:79], a[180:183], v[44:47], v[76:79]
v_cndmask_b32 v33, v33, v70, s[50:51]
v_mfma_f32_16x16x32_bf16 v[76:79], a[184:187], v[48:51], v[76:79]
v_cndmask_b32 v33, v33, v71, s[52:53]
v_add_f32_dpp v32, v32, v32 quad_perm:[2,3,0,1] row_mask:0xf bank_mask:0xf
v_mfma_f32_16x16x32_bf16 v[76:79], a[188:191], v[52:55], v[76:79]
v_max3_f32 v18, v18, v30, v31
v_mfma_f32_16x16x32_bf16 v[64:67], a[192:195], v[40:43], 0
v_cndmask_b32 v34, v72, v73, s[48:49]
v_add_f32_dpp v33, v33, v33 quad_perm:[1,0,3,2] row_mask:0xf bank_mask:0xf
v_mfma_f32_16x16x32_bf16 v[64:67], a[196:199], v[44:47], v[64:67]
v_cndmask_b32 v34, v34, v74, s[50:51]
v_mfma_f32_16x16x32_bf16 v[64:67], a[200:203], v[48:51], v[64:67]
v_cndmask_b32 v34, v34, v75, s[52:53]
v_add_f32_dpp v33, v33, v33 quad_perm:[2,3,0,1] row_mask:0xf bank_mask:0xf
v_mfma_f32_16x16x32_bf16 v[64:67], a[204:207], v[52:55], v[64:67]
v_mfma_f32_16x16x32_bf16 v[68:71], a[208:211], v[40:43], 0
v_cndmask_b32 v35, v76, v77, s[48:49]
v_add_f32_dpp v34, v34, v34 quad_perm:[1,0,3,2] row_mask:0xf bank_mask:0xf
v_mfma_f32_16x16x32_bf16 v[68:71], a[212:215], v[44:47], v[68:71]
v_cndmask_b32 v35, v35, v78, s[50:51]
v_mfma_f32_16x16x32_bf16 v[68:71], a[216:219], v[48:51], v[68:71]
v_cndmask_b32 v35, v35, v79, s[52:53]
v_add_f32_dpp v34, v34, v34 quad_perm:[2,3,0,1] row_mask:0xf bank_mask:0xf
v_mfma_f32_16x16x32_bf16 v[68:71], a[220:223], v[52:55], v[68:71]
v_max3_f32 v18, v18, v32, v33
v_mfma_f32_16x16x32_bf16 v[72:75], a[224:227], v[40:43], 0
v_cndmask_b32 v36, v64, v65, s[48:49]
v_add_f32_dpp v35, v35, v35 quad_perm:[1,0,3,2] row_mask:0xf bank_mask:0xf
v_mfma_f32_16x16x32_bf16 v[72:75], a[228:231], v[44:47], v[72:75]
v_cndmask_b32 v36, v36, v66, s[50:51]
v_mfma_f32_16x16x32_bf16 v[72:75], a[232:235], v[48:51], v[72:75]
v_cndmask_b32 v36, v36, v67, s[52:53]
v_add_f32_dpp v35, v35, v35 quad_perm:[2,3,0,1] row_mask:0xf bank_mask:0xf
v_mfma_f32_16x16x32_bf16 v[72:75], a[236:239], v[52:55], v[72:75]
v_mfma_f32_16x16x32_bf16 v[76:79], a[240:243], v[40:43], 0
v_cndmask_b32 v37, v68, v69, s[48:49]
v_add_f32_dpp v36, v36, v36 quad_perm:[1,0,3,2] row_mask:0xf bank_mask:0xf
v_mfma_f32_16x16x32_bf16 v[76:79], a[244:247], v[44:47], v[76:79]
v_cndmask_b32 v37, v37, v70, s[50:51]
v_mfma_f32_16x16x32_bf16 v[76:79], a[248:251], v[48:51], v[76:79]
v_cndmask_b32 v37, v37, v71, s[52:53]
v_add_f32_dpp v36, v36, v36 quad_perm:[2,3,0,1] row_mask:0xf bank_mask:0xf
v_mfma_f32_16x16x32_bf16 v[76:79], a[252:255], v[52:55], v[76:79]
v_max3_f32 v18, v18, v34, v35
v_cndmask_b32 v38, v72, v73, s[48:49]
v_add_f32_dpp v37, v37, v37 quad_perm:[1,0,3,2] row_mask:0xf bank_mask:0xf
v_cndmask_b32 v38, v38, v74, s[50:51]
v_cndmask_b32 v38, v38, v75, s[52:53]
v_add_f32_dpp v37, v37, v37 quad_perm:[2,3,0,1] row_mask:0xf bank_mask:0xf
s_nop 1
v_cndmask_b32 v39, v76, v77, s[48:49]
v_add_f32_dpp v38, v38, v38 quad_perm:[1,0,3,2] row_mask:0xf bank_mask:0xf
v_cndmask_b32 v39, v39, v78, s[50:51]
v_cndmask_b32 v39, v39, v79, s[52:53]
v_add_f32_dpp v38, v38, v38 quad_perm:[2,3,0,1] row_mask:0xf bank_mask:0xf
v_max3_f32 v18, v18, v36, v37
v_add_f32_dpp v39, v39, v39 quad_perm:[1,0,3,2] row_mask:0xf bank_mask:0xf
s_nop 1
v_add_f32_dpp v39, v39, v39 quad_perm:[2,3,0,1] row_mask:0xf bank_mask:0xf
v_max3_f32 v18, v18, v38, v39
s_nop 1
v_max_f32_dpp v18, v18, v18 row_ror:8 row_mask:0xf bank_mask:0xf
s_cmp_eq_u32 s34, 0
s_cbranch_scc1 VJ_16
s_waitcnt vmcnt(0)
s_branch VI_15
VJ_16:
s_add_u32 s68, s35, 786432
s_add_u32 m0, s3, 24576
s_nop 0
buffer_load_dwordx4 v12, s[12:15], s68 offen offset:0 nt lds
s_add_u32 m0, s3, 25344
s_nop 0
buffer_load_dwordx4 v12, s[12:15], s68 offen offset:256 nt lds
s_add_u32 m0, s3, 26112
s_nop 0
buffer_load_dwordx4 v12, s[12:15], s68 offen offset:512 nt lds
s_add_u32 m0, s3, 26880
s_nop 0
buffer_load_dwordx4 v12, s[12:15], s68 offen offset:768 nt lds
s_add_u32 m0, s3, 27648
s_nop 0
buffer_load_dwordx4 v12, s[12:15], s68 offen offset:1024 nt lds
s_add_u32 m0, s3, 28416
s_nop 0
buffer_load_dwordx4 v12, s[12:15], s68 offen offset:1280 nt lds
s_add_u32 m0, s3, 29184
s_nop 0
buffer_load_dwordx4 v12, s[12:15], s68 offen offset:1536 nt lds
s_add_u32 m0, s3, 29952
s_nop 0
buffer_load_dwordx4 v12, s[12:15], s68 offen offset:1792 nt lds
VI_15:
v_mov_b32 v19, v18
s_waitcnt vmcnt(24)
ds_read_b128 v[48:51], v17 offset:0
ds_read_b128 v[52:55], v17 offset:1024
ds_read_b128 v[64:67], v17 offset:2048
ds_read_b128 v[68:71], v17 offset:3072
ds_read_b128 v[72:75], v17 offset:4096
ds_read_b128 v[76:79], v17 offset:5120
v_permlane16_swap_b32 v18, v19
v_max_f32 v18, v18, v19
v_mov_b32 v19, v18
s_nop 1
v_permlane32_swap_b32 v18, v19
v_max_f32 v18, v18, v19
v_sub_f32 v24, v24, v18
v_exp_f32 v24, v24
s_nop 0
v_cvt_pk_bf16_f32 v16, v24, v24
v_mov_b32 v19, v24
v_and_b32 v56, v20, v16
v_and_b32 v57, v21, v16
v_and_b32 v58, v22, v16
v_and_b32 v59, v23, v16
v_sub_f32 v25, v25, v18
v_exp_f32 v25, v25
ds_read_b128 v[80:83], v17 offset:6144
ds_read_b128 v[84:87], v17 offset:7168
s_waitcnt lgkmcnt(6)
v_mfma_f32_16x16x32_bf16 v[4:7], v[48:51], v[56:59], 0
v_cvt_pk_bf16_f32 v13, v25, v25
v_add_f32 v19, v19, v25
v_mfma_f32_16x16x32_bf16 v[8:11], v[52:55], v[56:59], 0
v_and_b32 v60, v20, v13
v_and_b32 v61, v21, v13
s_waitcnt vmcnt(16)
ds_read_b128 v[48:51], v17 offset:8192
ds_read_b128 v[52:55], v17 offset:9216
s_waitcnt lgkmcnt(6)
v_mfma_f32_16x16x32_bf16 v[40:43], v[64:67], v[56:59], 0
v_and_b32 v62, v22, v13
v_and_b32 v63, v23, v13
v_mfma_f32_16x16x32_bf16 v[44:47], v[68:71], v[56:59], 0
v_sub_f32 v26, v26, v18
v_exp_f32 v26, v26
ds_read_b128 v[64:67], v17 offset:10240
ds_read_b128 v[68:71], v17 offset:11264
s_waitcnt lgkmcnt(6)
v_mfma_f32_16x16x32_bf16 v[4:7], v[72:75], v[60:63], v[4:7]
v_cvt_pk_bf16_f32 v16, v26, v26
v_add_f32 v19, v19, v26
v_mfma_f32_16x16x32_bf16 v[8:11], v[76:79], v[60:63], v[8:11]
v_and_b32 v56, v20, v16
v_and_b32 v57, v21, v16
ds_read_b128 v[72:75], v17 offset:12288
ds_read_b128 v[76:79], v17 offset:13312
s_waitcnt lgkmcnt(6)
v_mfma_f32_16x16x32_bf16 v[40:43], v[80:83], v[60:63], v[40:43]
v_and_b32 v58, v22, v16
v_and_b32 v59, v23, v16
v_mfma_f32_16x16x32_bf16 v[44:47], v[84:87], v[60:63], v[44:47]
v_sub_f32 v27, v27, v18
v_exp_f32 v27, v27
s_cmp_eq_u32 s34, 0
s_cbranch_scc0 VI_17
s_add_u32 s68, s35, 1048576
s_add_u32 m0, s3, 32768
s_nop 0
buffer_load_dwordx4 v12, s[12:15], s68 offen offset:0 nt lds
s_add_u32 m0, s3, 33536
s_nop 0
buffer_load_dwordx4 v12, s[12:15], s68 offen offset:256 nt lds
s_add_u32 m0, s3, 34304
s_nop 0
buffer_load_dwordx4 v12, s[12:15], s68 offen offset:512 nt lds
s_add_u32 m0, s3, 35072
s_nop 0
buffer_load_dwordx4 v12, s[12:15], s68 offen offset:768 nt lds
s_add_u32 m0, s3, 35840
s_nop 0
buffer_load_dwordx4 v12, s[12:15], s68 offen offset:1024 nt lds
s_add_u32 m0, s3, 36608
s_nop 0
buffer_load_dwordx4 v12, s[12:15], s68 offen offset:1280 nt lds
buffer_load_dwordx4 v[152:155], v12, s[12:15], s68 offen offset:1536 nt
buffer_load_dwordx4 v[156:159], v12, s[12:15], s68 offen offset:1792 nt
v_and_b32 v3, 7, v0
v_lshlrev_b32 v3, 5, v3
s_mov_b64 exec, 0xff
global_load_dwordx2 v[14:15], v3, s[18:19] sc1
s_mov_b64 exec, -1
VI_17:
ds_read_b128 v[80:83], v17 offset:14336
ds_read_b128 v[84:87], v17 offset:15360
s_waitcnt lgkmcnt(6)
v_mfma_f32_16x16x32_bf16 v[4:7], v[48:51], v[56:59], v[4:7]
v_cvt_pk_bf16_f32 v13, v27, v27
v_add_f32 v19, v19, v27
v_mfma_f32_16x16x32_bf16 v[8:11], v[52:55], v[56:59], v[8:11]
v_and_b32 v60, v20, v13
v_and_b32 v61, v21, v13
s_waitcnt vmcnt(17)
ds_read_b128 v[48:51], v17 offset:16384
ds_read_b128 v[52:55], v17 offset:17408
s_waitcnt lgkmcnt(6)
v_mfma_f32_16x16x32_bf16 v[40:43], v[64:67], v[56:59], v[40:43]
v_and_b32 v62, v22, v13
v_and_b32 v63, v23, v13
v_mfma_f32_16x16x32_bf16 v[44:47], v[68:71], v[56:59], v[44:47]
v_sub_f32 v28, v28, v18
v_exp_f32 v28, v28
ds_read_b128 v[64:67], v17 offset:18432
ds_read_b128 v[68:71], v17 offset:19456
s_waitcnt lgkmcnt(6)
v_mfma_f32_16x16x32_bf16 v[4:7], v[72:75], v[60:63], v[4:7]
v_cvt_pk_bf16_f32 v16, v28, v28
v_add_f32 v19, v19, v28
v_mfma_f32_16x16x32_bf16 v[8:11], v[76:79], v[60:63], v[8:11]
v_and_b32 v56, v20, v16
v_and_b32 v57, v21, v16
ds_read_b128 v[72:75], v17 offset:20480
ds_read_b128 v[76:79], v17 offset:21504
s_waitcnt lgkmcnt(6)
v_mfma_f32_16x16x32_bf16 v[40:43], v[80:83], v[60:63], v[40:43]
v_and_b32 v58, v22, v16
v_and_b32 v59, v23, v16
v_mfma_f32_16x16x32_bf16 v[44:47], v[84:87], v[60:63], v[44:47]
v_sub_f32 v29, v29, v18
v_exp_f32 v29, v29
s_cmp_eq_u32 s34, 0
s_cbranch_scc0 VI_18
s_add_u32 s68, s35, 1310720
buffer_load_dwordx4 v[160:163], v12, s[12:15], s68 offen offset:0 nt
buffer_load_dwordx4 v[164:167], v12, s[12:15], s68 offen offset:256 nt
buffer_load_dwordx4 v[168:171], v12, s[12:15], s68 offen offset:512 nt
buffer_load_dwordx4 v[172:175], v12, s[12:15], s68 offen offset:768 nt
buffer_load_dwordx4 v[176:179], v12, s[12:15], s68 offen offset:1024 nt
buffer_load_dwordx4 v[180:183], v12, s[12:15], s68 offen offset:1280 nt
buffer_load_dwordx4 v[184:187], v12, s[12:15], s68 offen offset:1536 nt
buffer_load_dwordx4 v[188:191], v12, s[12:15], s68 offen offset:1792 nt
VI_18:
ds_read_b128 v[80:83], v17 offset:22528
ds_read_b128 v[84:87], v17 offset:23552
s_waitcnt lgkmcnt(6)
v_mfma_f32_16x16x32_bf16 v[4:7], v[48:51], v[56:59], v[4:7]
v_cvt_pk_bf16_f32 v13, v29, v29
v_add_f32 v19, v19, v29
v_mfma_f32_16x16x32_bf16 v[8:11], v[52:55], v[56:59], v[8:11]
v_and_b32 v60, v20, v13
v_and_b32 v61, v21, v13
s_waitcnt vmcnt(17)
ds_read_b128 v[48:51], v17 offset:24576
ds_read_b128 v[52:55], v17 offset:25600
s_waitcnt lgkmcnt(6)
v_mfma_f32_16x16x32_bf16 v[40:43], v[64:67], v[56:59], v[40:43]
v_and_b32 v62, v22, v13
v_and_b32 v63, v23, v13
v_mfma_f32_16x16x32_bf16 v[44:47], v[68:71], v[56:59], v[44:47]
v_sub_f32 v30, v30, v18
v_exp_f32 v30, v30
ds_read_b128 v[64:67], v17 offset:26624
ds_read_b128 v[68:71], v17 offset:27648
s_waitcnt lgkmcnt(6)
v_mfma_f32_16x16x32_bf16 v[4:7], v[72:75], v[60:63], v[4:7]
v_cvt_pk_bf16_f32 v16, v30, v30
v_add_f32 v19, v19, v30
v_mfma_f32_16x16x32_bf16 v[8:11], v[76:79], v[60:63], v[8:11]
v_and_b32 v56, v20, v16
v_and_b32 v57, v21, v16
ds_read_b128 v[72:75], v17 offset:28672
ds_read_b128 v[76:79], v17 offset:29696
s_waitcnt lgkmcnt(6)
v_mfma_f32_16x16x32_bf16 v[40:43], v[80:83], v[60:63], v[40:43]
v_and_b32 v58, v22, v16
v_and_b32 v59, v23, v16
v_mfma_f32_16x16x32_bf16 v[44:47], v[84:87], v[60:63], v[44:47]
v_sub_f32 v31, v31, v18
v_exp_f32 v31, v31
s_cmp_eq_u32 s34, 0
s_cbranch_scc0 VI_19
s_add_u32 s68, s35, 1572864
buffer_load_dwordx4 v[192:195], v12, s[12:15], s68 offen offset:0 nt
buffer_load_dwordx4 v[196:199], v12, s[12:15], s68 offen offset:256 nt
buffer_load_dwordx4 v[200:203], v12, s[12:15], s68 offen offset:512 nt
buffer_load_dwordx4 v[204:207], v12, s[12:15], s68 offen offset:768 nt
buffer_load_dwordx4 v[208:211], v12, s[12:15], s68 offen offset:1024 nt
buffer_load_dwordx4 v[212:215], v12, s[12:15], s68 offen offset:1280 nt
buffer_load_dwordx4 v[216:219], v12, s[12:15], s68 offen offset:1536 nt
buffer_load_dwordx4 v[220:223], v12, s[12:15], s68 offen offset:1792 nt
VI_19:
ds_read_b128 v[80:83], v17 offset:30720
ds_read_b128 v[84:87], v17 offset:31744
s_waitcnt lgkmcnt(6)
v_mfma_f32_16x16x32_bf16 v[4:7], v[48:51], v[56:59], v[4:7]
v_cvt_pk_bf16_f32 v13, v31, v31
v_add_f32 v19, v19, v31
v_mfma_f32_16x16x32_bf16 v[8:11], v[52:55], v[56:59], v[8:11]
v_and_b32 v60, v20, v13
v_and_b32 v61, v21, v13
s_waitcnt vmcnt(17)
ds_read_b128 v[48:51], v17 offset:32768
ds_read_b128 v[52:55], v17 offset:33792
s_waitcnt lgkmcnt(6)
v_mfma_f32_16x16x32_bf16 v[40:43], v[64:67], v[56:59], v[40:43]
v_and_b32 v62, v22, v13
v_and_b32 v63, v23, v13
v_mfma_f32_16x16x32_bf16 v[44:47], v[68:71], v[56:59], v[44:47]
v_sub_f32 v32, v32, v18
v_exp_f32 v32, v32
ds_read_b128 v[64:67], v17 offset:34816
ds_read_b128 v[68:71], v17 offset:35840
s_waitcnt lgkmcnt(6)
v_mfma_f32_16x16x32_bf16 v[4:7], v[72:75], v[60:63], v[4:7]
v_cvt_pk_bf16_f32 v16, v32, v32
v_add_f32 v19, v19, v32
v_mfma_f32_16x16x32_bf16 v[8:11], v[76:79], v[60:63], v[8:11]
v_and_b32 v56, v20, v16
v_and_b32 v57, v21, v16
ds_read_b128 v[72:75], v17 offset:36864
ds_read_b128 v[76:79], v17 offset:37888
s_waitcnt lgkmcnt(6)
v_mfma_f32_16x16x32_bf16 v[40:43], v[80:83], v[60:63], v[40:43]
v_and_b32 v58, v22, v16
v_and_b32 v59, v23, v16
v_mfma_f32_16x16x32_bf16 v[44:47], v[84:87], v[60:63], v[44:47]
v_sub_f32 v33, v33, v18
v_exp_f32 v33, v33
s_cmp_eq_u32 s34, 0
s_cbranch_scc0 VI_20
s_add_u32 s68, s35, 1835008
buffer_load_dwordx4 v[224:227], v12, s[12:15], s68 offen offset:0 nt
buffer_load_dwordx4 v[228:231], v12, s[12:15], s68 offen offset:256 nt
buffer_load_dwordx4 v[232:235], v12, s[12:15], s68 offen offset:512 nt
buffer_load_dwordx4 v[236:239], v12, s[12:15], s68 offen offset:768 nt
buffer_load_dwordx4 v[240:243], v12, s[12:15], s68 offen offset:1024 nt
buffer_load_dwordx4 v[244:247], v12, s[12:15], s68 offen offset:1280 nt
buffer_load_dwordx4 v[248:251], v12, s[12:15], s68 offen offset:1536 nt
buffer_load_dwordx4 v[252:255], v12, s[12:15], s68 offen offset:1792 nt
VI_20:
s_waitcnt lgkmcnt(4)
v_mfma_f32_16x16x32_bf16 v[4:7], v[48:51], v[56:59], v[4:7]
v_cvt_pk_bf16_f32 v13, v33, v33
v_add_f32 v19, v19, v33
v_mfma_f32_16x16x32_bf16 v[8:11], v[52:55], v[56:59], v[8:11]
v_and_b32 v60, v20, v13
v_and_b32 v61, v21, v13
s_waitcnt lgkmcnt(2)
v_mfma_f32_16x16x32_bf16 v[40:43], v[64:67], v[56:59], v[40:43]
v_and_b32 v62, v22, v13
v_and_b32 v63, v23, v13
v_mfma_f32_16x16x32_bf16 v[44:47], v[68:71], v[56:59], v[44:47]
v_sub_f32 v34, v34, v18
v_exp_f32 v34, v34
s_waitcnt lgkmcnt(0)
v_mfma_f32_16x16x32_bf16 v[4:7], v[72:75], v[60:63], v[4:7]
v_cvt_pk_bf16_f32 v16, v34, v34
v_add_f32 v19, v19, v34
v_mfma_f32_16x16x32_bf16 v[8:11], v[76:79], v[60:63], v[8:11]
v_and_b32 v56, v20, v16
v_and_b32 v57, v21, v16
s_waitcnt vmcnt(25)
v_mfma_f32_16x16x32_bf16 v[40:43], v[152:155], v[60:63], v[40:43]
v_and_b32 v58, v22, v16
v_and_b32 v59, v23, v16
v_mfma_f32_16x16x32_bf16 v[44:47], v[156:159], v[60:63], v[44:47]
v_sub_f32 v35, v35, v18
v_exp_f32 v35, v35
s_waitcnt vmcnt(16)
v_mfma_f32_16x16x32_bf16 v[4:7], v[160:163], v[56:59], v[4:7]
v_cvt_pk_bf16_f32 v13, v35, v35
v_add_f32 v19, v19, v35
v_mfma_f32_16x16x32_bf16 v[8:11], v[164:167], v[56:59], v[8:11]
v_and_b32 v60, v20, v13
v_and_b32 v61, v21, v13
v_mfma_f32_16x16x32_bf16 v[40:43], v[168:171], v[56:59], v[40:43]
v_and_b32 v62, v22, v13
v_and_b32 v63, v23, v13
v_mfma_f32_16x16x32_bf16 v[44:47], v[172:175], v[56:59], v[44:47]
v_sub_f32 v36, v36, v18
v_exp_f32 v36, v36
v_mfma_f32_16x16x32_bf16 v[4:7], v[176:179], v[60:63], v[4:7]
v_cvt_pk_bf16_f32 v16, v36, v36
v_add_f32 v19, v19, v36
v_mfma_f32_16x16x32_bf16 v[8:11], v[180:183], v[60:63], v[8:11]
v_and_b32 v56, v20, v16
v_and_b32 v57, v21, v16
v_mfma_f32_16x16x32_bf16 v[40:43], v[184:187], v[60:63], v[40:43]
v_and_b32 v58, v22, v16
v_and_b32 v59, v23, v16
v_mfma_f32_16x16x32_bf16 v[44:47], v[188:191], v[60:63], v[44:47]
v_sub_f32 v37, v37, v18
v_exp_f32 v37, v37
s_waitcnt vmcnt(8)
s_cmp_eq_u32 s34, 0
s_cbranch_scc0 L_gb_done
s_mov_b64 exec, 0xff
L_gb:
v_lshrrev_b32 v3, 24, v15
v_cmp_ne_u32 vcc, 32, v3
s_cbranch_vccz L_gb_d
s_cmp_eq_u32 s33, 0
s_cbranch_scc1 L_gb_d
s_sub_u32 s33, s33, 1
s_sleep 4
v_and_b32 v3, 7, v0
v_lshlrev_b32 v3, 5, v3
global_load_dwordx2 v[14:15], v3, s[18:19] sc1
s_waitcnt vmcnt(0)
s_branch L_gb
L_gb_d:
s_mov_b64 exec, -1
s_getreg_b32 s68, hwreg(HW_REG_XCC_ID, 0, 4)
s_and_b32 s68, s68, 7
s_mul_i32 s68, s68, 6
s_lshl_b64 s[78:79], 32, s68
s_or_b32 s79, s79, 0x20000000
v_readlane_b32 s68, v14, s27
v_readlane_b32 s69, v15, s27
s_nop 0
s_cmp_eq_u64 s[68:69], s[78:79]
s_cselect_b32 s32, 1, 0
L_gb_done:
v_lshrrev_b32 v12, 4, v0
v_lshlrev_b32 v12, 7, v12
v_and_b32 v3, 15, v0
v_lshl_add_u32 v12, v3, 4, v12
s_lshl_b32 s68, s26, 10
s_add_u32 s68, s68, 155648
v_add_u32 v12, s68, v12
s_lshl_b32 s68, s26, 3
s_add_u32 s68, s68, 159744
v_mov_b32 v14, s68
v_mfma_f32_16x16x32_bf16 v[4:7], v[192:195], v[56:59], v[4:7]
v_cvt_pk_bf16_f32 v13, v37, v37
v_add_f32 v19, v19, v37
v_mfma_f32_16x16x32_bf16 v[8:11], v[196:199], v[56:59], v[8:11]
v_and_b32 v60, v20, v13
v_and_b32 v61, v21, v13
v_mfma_f32_16x16x32_bf16 v[40:43], v[200:203], v[56:59], v[40:43]
v_and_b32 v62, v22, v13
v_and_b32 v63, v23, v13
v_mfma_f32_16x16x32_bf16 v[44:47], v[204:207], v[56:59], v[44:47]
v_sub_f32 v38, v38, v18
v_exp_f32 v38, v38
v_mfma_f32_16x16x32_bf16 v[4:7], v[208:211], v[60:63], v[4:7]
v_cvt_pk_bf16_f32 v16, v38, v38
v_add_f32 v19, v19, v38
v_mfma_f32_16x16x32_bf16 v[8:11], v[212:215], v[60:63], v[8:11]
v_and_b32 v56, v20, v16
v_and_b32 v57, v21, v16
v_mfma_f32_16x16x32_bf16 v[40:43], v[216:219], v[60:63], v[40:43]
v_and_b32 v58, v22, v16
v_and_b32 v59, v23, v16
v_mfma_f32_16x16x32_bf16 v[44:47], v[220:223], v[60:63], v[44:47]
v_sub_f32 v39, v39, v18
v_exp_f32 v39, v39
s_waitcnt vmcnt(6)
v_mfma_f32_16x16x32_bf16 v[4:7], v[224:227], v[56:59], v[4:7]
v_cvt_pk_bf16_f32 v13, v39, v39
v_add_f32 v19, v19, v39
v_mfma_f32_16x16x32_bf16 v[8:11], v[228:231], v[56:59], v[8:11]
v_and_b32 v60, v20, v13
v_and_b32 v61, v21, v13
s_waitcnt vmcnt(4)
v_mfma_f32_16x16x32_bf16 v[40:43], v[232:235], v[56:59], v[40:43]
v_and_b32 v62, v22, v13
v_and_b32 v63, v23, v13
v_mfma_f32_16x16x32_bf16 v[44:47], v[236:239], v[56:59], v[44:47]
s_waitcnt vmcnt(2)
v_mfma_f32_16x16x32_bf16 v[4:7], v[240:243], v[60:63], v[4:7]
v_mfma_f32_16x16x32_bf16 v[8:11], v[244:247], v[60:63], v[8:11]
s_waitcnt vmcnt(0)
v_mfma_f32_16x16x32_bf16 v[40:43], v[248:251], v[60:63], v[40:43]
v_mfma_f32_16x16x32_bf16 v[44:47], v[252:255], v[60:63], v[44:47]
v_add_f32_dpp v19, v19, v19 row_ror:8 row_mask:0xf bank_mask:0xf
v_mov_b32 v13, v19
s_nop 1
v_permlane16_swap_b32 v19, v13
v_add_f32 v19, v19, v13
v_mov_b32 v13, v19
s_nop 1
v_permlane32_swap_b32 v19, v13
v_add_f32 v19, v19, v13
v_add_f32_dpp v4, v40, v4 row_ror:8 row_mask:0xf bank_mask:0xf
v_add_f32_dpp v5, v41, v5 row_ror:8 row_mask:0xf bank_mask:0xf
v_add_f32_dpp v6, v42, v6 row_ror:8 row_mask:0xf bank_mask:0xf
v_add_f32_dpp v7, v43, v7 row_ror:8 row_mask:0xf bank_mask:0xf
v_add_f32_dpp v8, v44, v8 row_ror:8 row_mask:0xf bank_mask:0xf
v_add_f32_dpp v9, v45, v9 row_ror:8 row_mask:0xf bank_mask:0xf
v_add_f32_dpp v10, v46, v10 row_ror:8 row_mask:0xf bank_mask:0xf
v_add_f32_dpp v11, v47, v11 row_ror:8 row_mask:0xf bank_mask:0xf
s_mov_b32 exec_lo, 0xff00ff
s_mov_b32 exec_hi, 0xff00ff
ds_write_b128 v12, v[4:7]
ds_write_b128 v12, v[8:11] offset:512
s_mov_b64 exec, 1
ds_write_b64 v14, v[18:19]
s_mov_b64 exec, -1
s_waitcnt lgkmcnt(0)
s_barrier
s_cmp_eq_u32 s26, 0
s_cbranch_scc0 L_nocomb
v_add_u32 v12, 155648, v2
ds_read_b128 v[24:27], v12 offset:0
ds_read_b128 v[28:31], v12 offset:1024
ds_read_b128 v[32:35], v12 offset:2048
ds_read_b128 v[36:39], v12 offset:3072
v_mov_b32 v13, 159744
ds_read_b128 v[40:43], v13
ds_read_b128 v[44:47], v13 offset:16
s_mul_i32 s68, s34, 32768
s_add_u32 s68, s68, 16384
s_add_u32 s70, s22, s68
s_addc_u32 s71, s23, 0
s_mul_i32 s68, s34, 32768
s_add_u32 s68, s68, 2048
s_add_u32 s72, s22, s68
s_addc_u32 s73, s23, 0
v_lshrrev_b32 v14, 3, v0
v_lshlrev_b32 v14, 10, v14
v_bfe_u32 v15, v0, 1, 2
v_lshl_add_u32 v14, v15, 8, v14
v_and_b32 v15, 1, v0
v_lshl_add_u32 v14, v15, 3, v14
s_lshl_b32 s68, s30, 3
s_add_u32 s68, s68, s31
s_lshl_b32 s68, s68, 4
s_lshl_b32 s78, s29, 13
s_add_u32 s68, s68, s78
v_add_u32 v14, s68, v14
s_lshl_b32 s68, s29, 7
s_lshl_b32 s78, s30, 6
s_add_u32 s68, s68, s78
s_lshl_b32 s78, s31, 3
s_add_u32 s68, s68, s78
v_mov_b32 v15, s68
s_waitcnt lgkmcnt(0)
v_max3_f32 v48, v40, v42, v44
v_max_f32 v48, v48, v46
v_sub_f32 v49, v40, v48
v_sub_f32 v50, v42, v48
v_sub_f32 v51, v44, v48
v_sub_f32 v52, v46, v48
v_exp_f32 v49, v49
v_exp_f32 v50, v50
v_exp_f32 v51, v51
v_exp_f32 v52, v52
v_mul_f32 v56, v49, v24
v_mul_f32 v57, v49, v25
v_mul_f32 v58, v49, v26
v_mul_f32 v59, v49, v27
v_fmac_f32 v56, v50, v28
v_fmac_f32 v57, v50, v29
v_fmac_f32 v58, v50, v30
v_fmac_f32 v59, v50, v31
v_fmac_f32 v56, v51, v32
v_fmac_f32 v57, v51, v33
v_fmac_f32 v58, v51, v34
v_fmac_f32 v59, v51, v35
v_fmac_f32 v56, v52, v36
v_fmac_f32 v57, v52, v37
v_fmac_f32 v58, v52, v38
v_fmac_f32 v59, v52, v39
v_cvt_pk_bf16_f32 v60, v56, v57
v_cvt_pk_bf16_f32 v61, v58, v59
s_cmp_eq_u32 s32, 1
s_cbranch_scc0 PUBS_21
global_store_dwordx2 v14, v[60:61], s[70:71]
PUBD_22:
v_mul_f32 v63, v49, v41
v_fmac_f32 v63, v50, v43
v_fmac_f32 v63, v51, v45
v_fmac_f32 v63, v52, v47
v_mov_b32 v62, v48
s_mov_b64 exec, 1
s_cmp_eq_u32 s32, 1
s_cbranch_scc0 PUBS_23
global_store_dwordx2 v15, v[62:63], s[72:73]
PUBD_24:
s_mov_b64 exec, -1
L_nocomb:
s_cmp_eq_u32 s6, 2
s_cbranch_scc1 L_gu_s
s_cmp_eq_u32 s6, 3
s_cbranch_scc1 L_dn_s
s_cmp_eq_u32 s6, 0
s_cbranch_scc1 L_wq_s
s_cmp_eq_u32 s6, 1
s_cbranch_scc0 L_next
s_mul_i32 s68, s34, 32768
s_add_u32 s68, s68, 16384
s_add_u32 s70, s22, s68
s_addc_u32 s71, s23, 0
s_mul_i32 s68, s34, 32768
s_add_u32 s68, s68, 2048
s_add_u32 s74, s22, s68
s_addc_u32 s75, s23, 0
s_lshl_b32 s68, s26, 12
s_add_u32 s70, s70, s68
s_addc_u32 s71, s71, 0
v_lshrrev_b32 v20, 5, v0
v_lshlrev_b32 v20, 6, v20
v_bfe_u32 v3, v0, 4, 1
v_lshl_add_u32 v20, v3, 5, v20
v_and_b32 v3, 3, v0
v_lshl_add_u32 v20, v3, 3, v20
s_lshr_b32 s68, s26, 1
s_lshl_b32 s68, s68, 7
v_add_u32 v20, s68, v20
v_bfe_u32 v21, v0, 4, 1
v_lshlrev_b32 v21, 7, v21
v_lshrrev_b32 v3, 5, v0
v_lshl_add_u32 v21, v3, 6, v21
v_and_b32 v3, 15, v0
v_lshl_add_u32 v21, v3, 2, v21
s_lshl_b32 s68, s26, 9
s_add_u32 s68, s68, 160384
v_add_u32 v21, s68, v21
v_lshrrev_b32 v22, 5, v0
v_lshlrev_b32 v22, 7, v22
v_and_b32 v3, 31, v0
v_lshl_add_u32 v22, v3, 2, v22
s_and_b32 s68, s26, 1
s_lshl_b32 s68, s68, 8
s_add_u32 s68, s68, 160384
v_add_u32 v22, s68, v22
s_cmp_ge_u32 s26, 2
s_cbranch_scc0 L_wo_nors
s_add_u32 s64, s22, 6144
s_addc_u32 s65, s23, 0
s_cmp_eq_u32 s34, 0
s_cselect_b32 s64, s4, s64
s_cselect_b32 s65, s5, s65
v_lshrrev_b32 v16, 5, v0
s_and_b32 s68, s26, 1
s_lshl_b32 s68, s68, 1
s_add_u32 s68, s68, s47
v_add_u32 v16, s68, v16
v_lshrrev_b32 v12, 5, v0
v_lshlrev_b32 v12, 10, v12
v_and_b32 v3, 31, v0
v_lshl_add_u32 v12, v3, 2, v12
s_and_b32 s68, s26, 1
s_lshl_b32 s68, s68, 11
v_add_u32 v12, s68, v12
v_bfe_u32 v3, v0, 4, 1
v_mul_u32_u24 v14, 896, v3
v_lshlrev_b32 v15, 8, v3
v_lshl_add_u32 v14, v16, 5, v14
v_lshl_add_u32 v15, v16, 3, v15
v_and_b32 v3, 15, v0
v_lshl_add_u32 v14, v3, 1, v14
v_mov_b32 v17, v1
s_cmp_eq_u32 s34, 0
s_cbranch_scc1 L_wo_nors
global_load_ushort v17, v14, s[64:65] sc1
L_wo_nors:
s_lshl_b32 s68, s34, 19
s_lshl_b32 s69, s47, 10
s_add_u32 s68, s68, s69
s_lshl_b32 s69, s27, 7
s_add_u32 s68, s68, s69
s_add_u32 s68, s68, 0
s_add_u32 s72, s24, s68
s_addc_u32 s73, s25, 0
v_lshrrev_b32 v13, 5, v0
v_lshlrev_b32 v13, 10, v13
v_and_b32 v3, 31, v0
v_lshl_add_u32 v13, v3, 2, v13
s_and_b32 s68, s26, 1
s_lshl_b32 s68, s68, 11
v_add_u32 v13, s68, v13
v_mov_b32 v60, 0
L_wo:
s_mov_b32 exec_lo, 0xf000f
s_mov_b32 exec_hi, 0xf000f
global_load_dwordx2 v[40:41], v20, s[74:75] sc1
s_mov_b64 exec, -1
global_load_dwordx4 v[24:27], v2, s[70:71] offset:0 sc1
global_load_dwordx4 v[28:31], v2, s[70:71] offset:1024 sc1
global_load_dwordx4 v[32:35], v2, s[70:71] offset:2048 sc1
global_load_dwordx4 v[36:39], v2, s[70:71] offset:3072 sc1
s_waitcnt vmcnt(4)
s_mov_b32 exec_lo, 0xf000f
s_mov_b32 exec_hi, 0xf000f
v_max_u32 v60, v40, v41
s_mov_b64 exec, -1
s_waitcnt vmcnt(0)
v_max3_u32 v62, v24, v25, v26
v_max3_u32 v62, v62, v27, v28
v_max3_u32 v62, v62, v29, v30
v_max3_u32 v62, v62, v31, v32
v_max3_u32 v62, v62, v33, v34
v_max3_u32 v62, v62, v35, v36
v_max3_u32 v62, v62, v37, v38
v_max3_u32 v62, v62, v39, v60
v_cmp_eq_u32 vcc, -1, v62
s_cbranch_vccz L_wo_d
s_cmp_eq_u32 s33, 0
s_cbranch_scc1 L_wo_d
s_sub_u32 s33, s33, 1
s_branch L_wo
L_wo_d:
v_mfma_f32_16x16x32_bf16 v[44:47], v[24:27], v[88:91], 0
v_mov_b32_dpp v62, v40 quad_perm:[1,0,3,2] row_mask:0xf bank_mask:0xf
v_mfma_f32_16x16x32_bf16 v[48:51], v[24:27], v[92:95], 0
v_max_f32 v61, v40, v62
v_mfma_f32_16x16x32_bf16 v[52:55], v[24:27], v[96:99], 0
s_nop 0
v_mov_b32_dpp v62, v61 quad_perm:[2,3,0,1] row_mask:0xf bank_mask:0xf
v_mfma_f32_16x16x32_bf16 v[56:59], v[24:27], v[100:103], 0
v_max_f32 v61, v61, v62
v_mfma_f32_16x16x32_bf16 v[44:47], v[28:31], v[104:107], v[44:47]
v_mov_b32 v62, v61
v_mfma_f32_16x16x32_bf16 v[48:51], v[28:31], v[108:111], v[48:51]
s_nop 0
v_permlane16_swap_b32 v61, v62
v_mfma_f32_16x16x32_bf16 v[52:55], v[28:31], v[112:115], v[52:55]
v_max_f32 v61, v61, v62
v_mfma_f32_16x16x32_bf16 v[56:59], v[28:31], v[116:119], v[56:59]
v_sub_f32 v63, v40, v61
v_mfma_f32_16x16x32_bf16 v[44:47], v[32:35], v[120:123], v[44:47]
v_exp_f32 v63, v63
v_mfma_f32_16x16x32_bf16 v[48:51], v[32:35], v[124:127], v[48:51]
v_mul_f32 v61, v63, v41
v_mfma_f32_16x16x32_bf16 v[52:55], v[32:35], v[128:131], v[52:55]
s_nop 0
v_mov_b32_dpp v62, v61 quad_perm:[1,0,3,2] row_mask:0xf bank_mask:0xf
v_mfma_f32_16x16x32_bf16 v[56:59], v[32:35], v[132:135], v[56:59]
v_add_f32 v61, v61, v62
v_mfma_f32_16x16x32_bf16 v[44:47], v[36:39], v[136:139], v[44:47]
s_nop 0
v_mov_b32_dpp v62, v61 quad_perm:[2,3,0,1] row_mask:0xf bank_mask:0xf
v_mfma_f32_16x16x32_bf16 v[48:51], v[36:39], v[140:143], v[48:51]
v_add_f32 v61, v61, v62
v_mfma_f32_16x16x32_bf16 v[52:55], v[36:39], v[144:147], v[52:55]
v_mov_b32 v62, v61
v_mfma_f32_16x16x32_bf16 v[56:59], v[36:39], v[148:151], v[56:59]
s_nop 0
v_permlane16_swap_b32 v61, v62
v_add_f32 v61, v61, v62
v_rcp_f32 v61, v61
s_nop 0
v_mul_f32 v64, v63, v61
s_nop 1
v_mul_f32_dpp v65, v64, v44 row_newbcast:0 row_mask:0xf bank_mask:0xf
v_mul_f32_dpp v66, v64, v48 row_newbcast:0 row_mask:0xf bank_mask:0xf
v_mul_f32_dpp v67, v64, v52 row_newbcast:0 row_mask:0xf bank_mask:0xf
v_mul_f32_dpp v68, v64, v56 row_newbcast:0 row_mask:0xf bank_mask:0xf
v_fmac_f32_dpp v65, v64, v45 row_newbcast:1 row_mask:0xf bank_mask:0xf
v_fmac_f32_dpp v66, v64, v49 row_newbcast:1 row_mask:0xf bank_mask:0xf
v_fmac_f32_dpp v67, v64, v53 row_newbcast:1 row_mask:0xf bank_mask:0xf
v_fmac_f32_dpp v68, v64, v57 row_newbcast:1 row_mask:0xf bank_mask:0xf
v_fmac_f32_dpp v65, v64, v46 row_newbcast:2 row_mask:0xf bank_mask:0xf
v_fmac_f32_dpp v66, v64, v50 row_newbcast:2 row_mask:0xf bank_mask:0xf
v_fmac_f32_dpp v67, v64, v54 row_newbcast:2 row_mask:0xf bank_mask:0xf
v_fmac_f32_dpp v68, v64, v58 row_newbcast:2 row_mask:0xf bank_mask:0xf
v_fmac_f32_dpp v65, v64, v47 row_newbcast:3 row_mask:0xf bank_mask:0xf
v_fmac_f32_dpp v66, v64, v51 row_newbcast:3 row_mask:0xf bank_mask:0xf
v_fmac_f32_dpp v67, v64, v55 row_newbcast:3 row_mask:0xf bank_mask:0xf
v_fmac_f32_dpp v68, v64, v59 row_newbcast:3 row_mask:0xf bank_mask:0xf
v_permlane16_swap_b32 v65, v66
s_nop 0
v_permlane16_swap_b32 v67, v68
v_add_f32 v65, v65, v66
v_add_f32 v67, v67, v68
ds_write_b32 v21, v65
ds_write_b32 v21, v67 offset:256
s_waitcnt lgkmcnt(0)
s_barrier
s_cmp_ge_u32 s26, 2
s_cbranch_scc1 L_wo_rs
ds_read_b32 v24, v22 offset:0
ds_read_b32 v25, v22 offset:512
ds_read_b32 v26, v22 offset:1024
ds_read_b32 v27, v22 offset:1536
s_waitcnt lgkmcnt(2)
v_add_f32 v24, v24, v25
s_waitcnt lgkmcnt(0)
v_add_f32 v26, v26, v27
v_add_f32 v24, v24, v26
global_store_dword v13, v24, s[72:73] sc1
s_add_u32 s72, s72, 0x8000
s_addc_u32 s73, s73, 0
global_store_dword v13, v24, s[72:73] sc1
s_add_u32 s72, s72, 0x8000
s_addc_u32 s73, s73, 0
global_store_dword v13, v24, s[72:73] sc1
s_add_u32 s72, s72, 0x8000
s_addc_u32 s73, s73, 0
global_store_dword v13, v24, s[72:73] sc1
s_add_u32 s72, s72, 0x8000
s_addc_u32 s73, s73, 0
global_store_dword v13, v24, s[72:73] sc1
s_add_u32 s72, s72, 0x8000
s_addc_u32 s73, s73, 0
global_store_dword v13, v24, s[72:73] sc1
s_add_u32 s72, s72, 0x8000
s_addc_u32 s73, s73, 0
global_store_dword v13, v24, s[72:73] sc1
s_add_u32 s72, s72, 0x8000
s_addc_u32 s73, s73, 0
global_store_dword v13, v24, s[72:73] sc1
s_branch L_next
L_wo_rs:
s_lshl_b32 s68, s34, 19
s_lshl_b32 s69, s47, 10
s_add_u32 s68, s68, s69
s_lshl_b32 s69, s27, 15
s_add_u32 s68, s68, s69
s_add_u32 s68, s68, 0
s_add_u32 s70, s24, s68
s_addc_u32 s71, s25, 0
s_mul_i32 s68, s34, 32768
s_add_u32 s68, s68, 2560
s_add_u32 s72, s22, s68
s_addc_u32 s73, s23, 0
s_mul_i32 s68, s34, 32768
s_add_u32 s68, s68, 4352
s_add_u32 s74, s22, s68
s_addc_u32 s75, s23, 0
s_mov_b32 s78, 0
s_sleep 10
L_rs_entry:
L_rs:
global_load_dword v24, v12, s[70:71] offset:0 sc1
global_load_dword v25, v12, s[70:71] offset:128 sc1
global_load_dword v26, v12, s[70:71] offset:256 sc1
global_load_dword v27, v12, s[70:71] offset:384 sc1
global_load_dword v28, v12, s[70:71] offset:512 sc1
global_load_dword v29, v12, s[70:71] offset:640 sc1
global_load_dword v30, v12, s[70:71] offset:768 sc1
global_load_dword v31, v12, s[70:71] offset:896 sc1
s_waitcnt vmcnt(0)
v_max3_u32 v8, v24, v25, v26
v_max3_u32 v8, v8, v27, v28
v_max3_u32 v8, v8, v29, v30
v_max_u32 v8, v8, v31
v_cmp_eq_u32 vcc, -1, v8
s_cbranch_vccz L_rs_ok0
s_cmp_eq_u32 s33, 0
s_cbranch_scc1 L_rs_ok0
s_sub_u32 s33, s33, 1
s_branch L_rs
L_rs_ok0:
v_add_f32 v4, v24, v25
v_add_f32 v5, v26, v27
v_add_f32 v6, v28, v29
v_add_f32 v7, v30, v31
L_rs_d:
v_cmp_eq_u32 vcc, 0xffff, v17
s_cbranch_vccz L_rsr_d
L_rsr:
global_load_ushort v17, v14, s[64:65] sc1
s_waitcnt vmcnt(0)
v_cmp_eq_u32 vcc, 0xffff, v17
s_cbranch_vccz L_rsr_d
s_cmp_eq_u32 s33, 0
s_cbranch_scc1 L_rsr_d
s_sub_u32 s33, s33, 1
s_branch L_rsr
L_rsr_d:
v_add_f32 v4, v4, v5
v_add_f32 v6, v6, v7
v_lshlrev_b32 v10, 16, v17
v_add_f32 v4, v4, v6
v_add_f32 v4, v10, v4
s_nop 1
v_mov_b32_dpp v6, v4 quad_perm:[1,0,3,2] row_mask:0xf bank_mask:0xf
v_cvt_pk_bf16_f32 v7, v4, v4
v_cvt_pk_bf16_f32 v5, v4, v6
s_cmp_eq_u32 s78, 1
s_cbranch_scc1 L_final
s_mov_b32 exec_lo, 0x55555555
s_mov_b32 exec_hi, 0x55555555
s_cmp_eq_u32 s32, 1
s_cbranch_scc0 PUBS_25
global_store_dword v14, v5, s[72:73]
PUBD_26:
s_mov_b64 exec, -1
v_and_b32 v6, 0xffff0000, v7
v_mul_f32 v7, v6, v6
s_nop 0
v_add_f32_dpp v6, v6, v6 row_shr:1 row_mask:0xf bank_mask:0xf
v_add_f32_dpp v7, v7, v7 row_shr:1 row_mask:0xf bank_mask:0xf
s_nop 0
v_add_f32_dpp v6, v6, v6 row_shr:2 row_mask:0xf bank_mask:0xf
v_add_f32_dpp v7, v7, v7 row_shr:2 row_mask:0xf bank_mask:0xf
s_nop 0
v_add_f32_dpp v6, v6, v6 row_shr:4 row_mask:0xf bank_mask:0xf
v_add_f32_dpp v7, v7, v7 row_shr:4 row_mask:0xf bank_mask:0xf
s_nop 0
v_add_f32_dpp v6, v6, v6 row_shr:8 row_mask:0xf bank_mask:0xf
v_add_f32_dpp v7, v7, v7 row_shr:8 row_mask:0xf bank_mask:0xf
s_mov_b32 exec_lo, 0x80008000
s_mov_b32 exec_hi, 0x80008000
s_cmp_eq_u32 s32, 1
s_cbranch_scc0 PUBS_27
global_store_dwordx2 v15, v[6:7], s[74:75]
PUBD_28:
s_mov_b64 exec, -1
s_waitcnt vmcnt(0)
s_branch L_next
L_gu_s:
s_mul_i32 s68, s34, 32768
s_add_u32 s68, s68, 4864
s_add_u32 s74, s22, s68
s_addc_u32 s75, s23, 0
v_bfe_u32 v11, v0, 4, 1
v_mul_u32_u24 v11, 448, v11
v_and_b32 v3, 15, v0
v_lshl_add_u32 v11, v3, 1, v11
s_lshl_b32 s68, s7, 4
v_add_u32 v11, s68, v11
v_and_b32 v12, 1, v0
v_mul_u32_u24 v12, 896, v12
v_lshrrev_b32 v3, 4, v0
v_lshl_add_u32 v12, v3, 4, v12
v_add_u32 v12, 160384, v12
v_bfe_u32 v13, v0, 4, 1
v_lshlrev_b32 v13, 8, v13
v_lshrrev_b32 v3, 5, v0
v_lshl_add_u32 v13, v3, 7, v13
v_and_b32 v3, 15, v0
v_lshl_add_u32 v13, v3, 3, v13
s_cmp_eq_u32 s26, 1
s_cbranch_scc0 L_gu_b
s_mul_i32 s68, s34, 32768
s_add_u32 s68, s68, 2560
s_add_u32 s70, s22, s68
s_addc_u32 s71, s23, 0
s_mul_i32 s68, s34, 32768
s_add_u32 s68, s68, 4352
s_add_u32 s72, s22, s68
s_addc_u32 s73, s23, 0
v_mov_b32 v20, 0
v_mov_b32 v21, 0
v_mov_b32 v22, 0
v_mov_b32 v23, 0
v_mov_b32 v82, 0
v_mov_b32 v83, 0
v_mov_b32 v148, 0
v_mov_b32 v149, 0
v_mov_b32 v150, 0
v_mov_b32 v151, 0
v_mov_b32 v18, 0
v_mov_b32 v19, 0
v_add_u32 v14, 160384, v2
v_add_u32 v16, 155648, v13
global_load_dwordx4 v[84:87], v2, s[70:71] sc1
s_mov_b32 exec_lo, 0xffffffff
s_mov_b32 exec_hi, 0xffff
global_load_dwordx4 v[20:23], v2, s[70:71] offset:1024 sc1
s_mov_b32 exec_lo, 0xffffffff
s_mov_b32 exec_hi, 0xfff0fff
global_load_dwordx2 v[82:83], v13, s[72:73] sc1
s_mov_b64 exec, -1
L_gu:
global_load_dwordx4 v[144:147], v2, s[70:71] sc1
s_mov_b32 exec_lo, 0xffffffff
s_mov_b32 exec_hi, 0xffff
global_load_dwordx4 v[148:151], v2, s[70:71] offset:1024 sc1
s_mov_b32 exec_lo, 0xffffffff
s_mov_b32 exec_hi, 0xfff0fff
global_load_dwordx2 v[18:19], v13, s[72:73] sc1
s_mov_b64 exec, -1
s_waitcnt vmcnt(3)
v_max3_u32 v17, v84, v85, v86
v_max3_u32 v17, v17, v87, v20
v_max3_u32 v17, v17, v21, v22
v_max3_u32 v17, v17, v23, v82
v_max_u32 v17, v17, v83
v_cmp_eq_u32 vcc, -1, v17
s_cbranch_vccz L_gu_ok0
global_load_dwordx4 v[84:87], v2, s[70:71] sc1
s_mov_b32 exec_lo, 0xffffffff
s_mov_b32 exec_hi, 0xffff
global_load_dwordx4 v[20:23], v2, s[70:71] offset:1024 sc1
s_mov_b32 exec_lo, 0xffffffff
s_mov_b32 exec_hi, 0xfff0fff
global_load_dwordx2 v[82:83], v13, s[72:73] sc1
s_mov_b64 exec, -1
s_waitcnt vmcnt(3)
v_max3_u32 v17, v144, v145, v146
v_max3_u32 v17, v17, v147, v148
v_max3_u32 v17, v17, v149, v150
v_max3_u32 v17, v17, v151, v18
v_max_u32 v17, v17, v19
v_cmp_eq_u32 vcc, -1, v17
s_cbranch_vccz L_gu_ok1
s_cmp_eq_u32 s33, 0
s_cbranch_scc1 L_gu_ok0
s_sub_u32 s33, s33, 1
s_branch L_gu
L_gu_ok1:
ds_write_b128 v14, v[144:147]
ds_write_b64 v16, v[18:19]
s_mov_b32 exec_lo, 0xffffffff
s_mov_b32 exec_hi, 0xffff
ds_write_b128 v14, v[148:151] offset:1024
s_mov_b64 exec, -1
s_branch L_gu_w
L_gu_ok0:
ds_write_b128 v14, v[84:87]
ds_write_b64 v16, v[82:83]
s_mov_b32 exec_lo, 0xffffffff
s_mov_b32 exec_hi, 0xffff
ds_write_b128 v14, v[20:23] offset:1024
s_mov_b64 exec, -1
L_gu_w:
s_waitcnt lgkmcnt(0)
L_gu_b:
s_barrier
v_add_u32 v13, 155648, v13
ds_read_b64 v[80:81], v13
ds_read_b128 v[24:27], v12 offset:0
ds_read_b128 v[28:31], v12 offset:64
ds_read_b128 v[32:35], v12 offset:128
ds_read_b128 v[36:39], v12 offset:192
ds_read_b128 v[40:43], v12 offset:256
ds_read_b128 v[44:47], v12 offset:320
ds_read_b128 v[48:51], v12 offset:384
ds_read_b128 v[52:55], v12 offset:448
ds_read_b128 v[56:59], v12 offset:512
ds_read_b128 v[60:63], v12 offset:576
ds_read_b128 v[64:67], v12 offset:640
ds_read_b128 v[68:71], v12 offset:704
ds_read_b128 v[72:75], v12 offset:768
ds_read_b128 v[76:79], v12 offset:832
s_waitcnt lgkmcnt(10)
v_mfma_f32_16x16x32_bf16 v[4:7], v[24:27], v[88:91], 0
v_add_f32_dpp v9, v80, v80 row_ror:8 row_mask:0xf bank_mask:0xf
v_add_f32_dpp v10, v81, v81 row_ror:8 row_mask:0xf bank_mask:0xf
v_mfma_f32_16x16x32_bf16 v[4:7], v[28:31], v[92:95], v[4:7]
v_add_f32_dpp v9, v9, v9 row_ror:4 row_mask:0xf bank_mask:0xf
v_mfma_f32_16x16x32_bf16 v[4:7], v[32:35], v[96:99], v[4:7]
v_add_f32_dpp v10, v10, v10 row_ror:4 row_mask:0xf bank_mask:0xf
v_add_f32_dpp v9, v9, v9 row_ror:2 row_mask:0xf bank_mask:0xf
v_mfma_f32_16x16x32_bf16 v[4:7], v[36:39], v[100:103], v[4:7]
v_add_f32_dpp v10, v10, v10 row_ror:2 row_mask:0xf bank_mask:0xf
s_waitcnt lgkmcnt(6)
v_mfma_f32_16x16x32_bf16 v[4:7], v[40:43], v[104:107], v[4:7]
v_add_f32_dpp v9, v9, v9 row_ror:1 row_mask:0xf bank_mask:0xf
v_add_f32_dpp v10, v10, v10 row_ror:1 row_mask:0xf bank_mask:0xf
v_mfma_f32_16x16x32_bf16 v[4:7], v[44:47], v[108:111], v[4:7]
v_mov_b32 v14, v9
v_mfma_f32_16x16x32_bf16 v[4:7], v[48:51], v[112:115], v[4:7]
v_mov_b32 v15, v10
v_permlane32_swap_b32 v9, v14
v_mfma_f32_16x16x32_bf16 v[4:7], v[52:55], v[116:119], v[4:7]
v_permlane32_swap_b32 v10, v15
s_waitcnt lgkmcnt(2)
v_mfma_f32_16x16x32_bf16 v[4:7], v[56:59], v[120:123], v[4:7]
v_add_f32 v9, v9, v14
v_add_f32 v10, v10, v15
v_mfma_f32_16x16x32_bf16 v[4:7], v[60:63], v[124:127], v[4:7]
v_mul_f32 v9, 0x3b124925, v9
v_mfma_f32_16x16x32_bf16 v[4:7], v[64:67], v[128:131], v[4:7]
v_mul_f32 v10, 0x3b124925, v10
v_fma_f32 v10, -v9, v9, v10
v_mfma_f32_16x16x32_bf16 v[4:7], v[68:71], v[132:135], v[4:7]
v_max_f32 v10, 0, v10
s_waitcnt lgkmcnt(0)
v_mfma_f32_16x16x32_bf16 v[4:7], v[72:75], v[136:139], v[4:7]
v_add_f32 v10, 0x3727c5ac, v10
v_rsq_f32 v10, v10
v_mfma_f32_16x16x32_bf16 v[4:7], v[76:79], v[140:143], v[4:7]
s_nop 7
v_permlane16_swap_b32 v4, v5
v_fma_f32 v8, -v9, v1, v4
v_mul_f32 v8, v8, v10
v_cvt_pk_bf16_f32 v8, v8, v8
v_and_b32 v8, 0xffff0000, v8
s_nop 1
v_mov_b32_dpp v9, v8 row_ror:8 row_mask:0xf bank_mask:0xf
v_max_f32 v8, 0, v8
v_mul_f32 v8, v8, v9
s_nop 1
v_mov_b32_dpp v10, v8 quad_perm:[1,0,3,2] row_mask:0xf bank_mask:0xf
v_cvt_pk_bf16_f32 v9, v8, v10
s_mov_b32 exec_lo, 0x550055
s_mov_b32 exec_hi, 0x0
s_cmp_eq_u32 s32, 1
s_cbranch_scc0 PUBS_29
global_store_dword v11, v9, s[74:75]
PUBD_30:
s_mov_b64 exec, -1
s_waitcnt vmcnt(0)
s_branch L_next
L_dn_s:
v_and_b32 v12, 1, v0
v_mul_u32_u24 v12, 448, v12
v_lshrrev_b32 v3, 4, v0
v_lshl_add_u32 v12, v3, 4, v12
v_add_u32 v12, 160384, v12
s_lshl_b32 s68, s34, 19
s_lshl_b32 s69, s47, 10
s_add_u32 s68, s68, s69
s_lshl_b32 s69, s27, 7
s_add_u32 s68, s68, s69
s_add_u32 s68, s68, 262144
s_add_u32 s72, s24, s68
s_addc_u32 s73, s25, 0
v_lshrrev_b32 v13, 5, v0
v_lshlrev_b32 v13, 10, v13
v_and_b32 v3, 31, v0
v_lshl_add_u32 v13, v3, 2, v13
s_and_b32 s68, s26, 1
s_lshl_b32 s68, s68, 11
v_add_u32 v13, s68, v13
s_cmp_eq_u32 s26, 1
s_cbranch_scc0 L_dn_b
s_mul_i32 s68, s34, 32768
s_add_u32 s68, s68, 4864
s_add_u32 s70, s22, s68
s_addc_u32 s71, s23, 0
v_add_u32 v14, 160384, v2
s_mov_b32 exec_lo, 0xffffffff
s_mov_b32 exec_hi, 0xffffff
global_load_dwordx4 v[80:83], v2, s[70:71] sc1
L_dn:
global_load_dwordx4 v[84:87], v2, s[70:71] sc1
s_waitcnt vmcnt(1)
v_max3_u32 v15, v80, v81, v82
v_max_u32 v15, v15, v83
v_cmp_eq_u32 vcc, -1, v15
s_cbranch_vccz L_dn_ok0
global_load_dwordx4 v[80:83], v2, s[70:71] sc1
s_waitcnt vmcnt(1)
v_max3_u32 v15, v84, v85, v86
v_max_u32 v15, v15, v87
v_cmp_eq_u32 vcc, -1, v15
s_cbranch_vccz L_dn_ok1
s_cmp_eq_u32 s33, 0
s_cbranch_scc1 L_dn_ok0
s_sub_u32 s33, s33, 1
s_branch L_dn
L_dn_ok1:
ds_write_b128 v14, v[84:87]
s_branch L_dn_w
L_dn_ok0:
ds_write_b128 v14, v[80:83]
L_dn_w:
s_mov_b64 exec, -1
s_waitcnt lgkmcnt(0)
L_dn_b:
s_barrier
s_cmp_ge_u32 s26, 2
s_cbranch_scc0 L_dn_nors
s_mul_i32 s68, s34, 32768
s_add_u32 s68, s68, 2560
s_add_u32 s64, s22, s68
s_addc_u32 s65, s23, 0
v_lshrrev_b32 v16, 5, v0
s_and_b32 s68, s26, 1
s_lshl_b32 s68, s68, 1
s_add_u32 s68, s68, s47
v_add_u32 v16, s68, v16
v_lshrrev_b32 v12, 5, v0
v_lshlrev_b32 v12, 10, v12
v_and_b32 v3, 31, v0
v_lshl_add_u32 v12, v3, 2, v12
s_and_b32 s68, s26, 1
s_lshl_b32 s68, s68, 11
v_add_u32 v12, s68, v12
v_bfe_u32 v3, v0, 4, 1
v_mul_u32_u24 v14, 896, v3
v_lshlrev_b32 v15, 8, v3
v_lshl_add_u32 v14, v16, 5, v14
v_lshl_add_u32 v15, v16, 3, v15
v_and_b32 v3, 15, v0
v_lshl_add_u32 v14, v3, 1, v14
global_load_ushort v17, v14, s[64:65] sc1
s_branch L_dn_rs
L_dn_nors:
ds_read_b128 v[24:27], v12 offset:0
ds_read_b128 v[28:31], v12 offset:64
ds_read_b128 v[32:35], v12 offset:128
ds_read_b128 v[36:39], v12 offset:192
ds_read_b128 v[40:43], v12 offset:256
ds_read_b128 v[44:47], v12 offset:320
ds_read_b128 v[48:51], v12 offset:384
s_waitcnt lgkmcnt(4)
v_mfma_f32_16x16x32_bf16 v[4:7], v[24:27], v[88:91], 0
v_mfma_f32_16x16x32_bf16 v[8:11], v[24:27], v[92:95], 0
v_mfma_f32_16x16x32_bf16 v[4:7], v[28:31], v[96:99], v[4:7]
v_mfma_f32_16x16x32_bf16 v[8:11], v[28:31], v[100:103], v[8:11]
v_mfma_f32_16x16x32_bf16 v[4:7], v[32:35], v[104:107], v[4:7]
v_mfma_f32_16x16x32_bf16 v[8:11], v[32:35], v[108:111], v[8:11]
s_waitcnt lgkmcnt(2)
v_mfma_f32_16x16x32_bf16 v[4:7], v[36:39], v[112:115], v[4:7]
v_mfma_f32_16x16x32_bf16 v[8:11], v[36:39], v[116:119], v[8:11]
v_mfma_f32_16x16x32_bf16 v[4:7], v[40:43], v[120:123], v[4:7]
v_mfma_f32_16x16x32_bf16 v[8:11], v[40:43], v[124:127], v[8:11]
s_waitcnt lgkmcnt(0)
v_mfma_f32_16x16x32_bf16 v[4:7], v[44:47], v[128:131], v[4:7]
v_mfma_f32_16x16x32_bf16 v[8:11], v[44:47], v[132:135], v[8:11]
v_mfma_f32_16x16x32_bf16 v[4:7], v[48:51], v[136:139], v[4:7]
v_mfma_f32_16x16x32_bf16 v[8:11], v[48:51], v[140:143], v[8:11]
s_nop 6
v_permlane16_swap_b32 v4, v5
v_permlane16_swap_b32 v8, v9
s_nop 1
v_permlane32_swap_b32 v4, v8
s_cmp_eq_u32 s34, 1
s_cbranch_scc1 L_dn_last
global_store_dword v13, v4, s[72:73] sc1
s_add_u32 s72, s72, 0x8000
s_addc_u32 s73, s73, 0
global_store_dword v13, v4, s[72:73] sc1
s_add_u32 s72, s72, 0x8000
s_addc_u32 s73, s73, 0
global_store_dword v13, v4, s[72:73] sc1
s_add_u32 s72, s72, 0x8000
s_addc_u32 s73, s73, 0
global_store_dword v13, v4, s[72:73] sc1
s_add_u32 s72, s72, 0x8000
s_addc_u32 s73, s73, 0
global_store_dword v13, v4, s[72:73] sc1
s_add_u32 s72, s72, 0x8000
s_addc_u32 s73, s73, 0
global_store_dword v13, v4, s[72:73] sc1
s_add_u32 s72, s72, 0x8000
s_addc_u32 s73, s73, 0
global_store_dword v13, v4, s[72:73] sc1
s_add_u32 s72, s72, 0x8000
s_addc_u32 s73, s73, 0
global_store_dword v13, v4, s[72:73] sc1
s_branch L_dn_pd
L_dn_last:
global_store_dword v13, v4, s[72:73] sc1
L_dn_pd:
s_waitcnt vmcnt(0)
s_branch L_next
L_dn_rs:
s_lshl_b32 s68, s34, 3
s_and_b32 s68, s68, 8
s_mul_i32 s68, s68, s27
s_cmp_lg_u32 s68, 0
s_cbranch_scc1 L_fin_w
s_lshl_b32 s68, s34, 19
s_lshl_b32 s69, s47, 10
s_add_u32 s68, s68, s69
s_lshl_b32 s69, s27, 15
s_add_u32 s68, s68, s69
s_add_u32 s68, s68, 262144
s_add_u32 s70, s24, s68
s_addc_u32 s71, s25, 0
s_mul_i32 s68, s34, 32768
s_add_u32 s68, s68, 6144
s_add_u32 s72, s22, s68
s_addc_u32 s73, s23, 0
s_mul_i32 s68, s34, 32768
s_add_u32 s68, s68, 7936
s_add_u32 s74, s22, s68
s_addc_u32 s75, s23, 0
s_mov_b32 s78, s34
s_cmp_eq_u32 s34, 1
s_cbranch_scc1 L_rs2b
s_sleep 12
s_branch L_rs_entry
L_rs2b:
s_sleep 11
s_branch L_rs_entry
L_wq_s:
s_cmp_eq_u32 s34, 1
s_cbranch_scc1 L_fin
s_add_u32 s74, s22, 32768
s_addc_u32 s75, s23, 0
v_bfe_u32 v11, v0, 4, 1
v_lshlrev_b32 v11, 10, v11
v_and_b32 v3, 15, v0
v_lshl_add_u32 v11, v3, 1, v11
s_lshl_b32 s68, s7, 5
v_add_u32 v11, s68, v11
v_and_b32 v12, 1, v0
v_mul_u32_u24 v12, 896, v12
v_lshrrev_b32 v3, 4, v0
v_lshl_add_u32 v12, v3, 4, v12
v_add_u32 v12, 160384, v12
v_bfe_u32 v13, v0, 4, 1
v_lshlrev_b32 v13, 8, v13
v_lshrrev_b32 v3, 5, v0
v_lshl_add_u32 v13, v3, 7, v13
v_and_b32 v3, 15, v0
v_lshl_add_u32 v13, v3, 3, v13
s_cmp_eq_u32 s26, 1
s_cbranch_scc0 L_qx_b
s_add_u32 s70, s22, 6144
s_addc_u32 s71, s23, 0
s_add_u32 s72, s22, 7936
s_addc_u32 s73, s23, 0
v_mov_b32 v20, 0
v_mov_b32 v21, 0
v_mov_b32 v22, 0
v_mov_b32 v23, 0
v_mov_b32 v82, 0
v_mov_b32 v83, 0
v_mov_b32 v148, 0
v_mov_b32 v149, 0
v_mov_b32 v150, 0
v_mov_b32 v151, 0
v_mov_b32 v18, 0
v_mov_b32 v19, 0
v_add_u32 v14, 160384, v2
v_add_u32 v16, 155648, v13
global_load_dwordx4 v[84:87], v2, s[70:71] sc1
s_mov_b32 exec_lo, 0xffffffff
s_mov_b32 exec_hi, 0xffff
global_load_dwordx4 v[20:23], v2, s[70:71] offset:1024 sc1
s_mov_b32 exec_lo, 0xffffffff
s_mov_b32 exec_hi, 0xfff0fff
global_load_dwordx2 v[82:83], v13, s[72:73] sc1
s_mov_b64 exec, -1
L_qx:
global_load_dwordx4 v[144:147], v2, s[70:71] sc1
s_mov_b32 exec_lo, 0xffffffff
s_mov_b32 exec_hi, 0xffff
global_load_dwordx4 v[148:151], v2, s[70:71] offset:1024 sc1
s_mov_b32 exec_lo, 0xffffffff
s_mov_b32 exec_hi, 0xfff0fff
global_load_dwordx2 v[18:19], v13, s[72:73] sc1
s_mov_b64 exec, -1
s_waitcnt vmcnt(3)
v_max3_u32 v17, v84, v85, v86
v_max3_u32 v17, v17, v87, v20
v_max3_u32 v17, v17, v21, v22
v_max3_u32 v17, v17, v23, v82
v_max_u32 v17, v17, v83
v_cmp_eq_u32 vcc, -1, v17
s_cbranch_vccz L_qx_ok0
global_load_dwordx4 v[84:87], v2, s[70:71] sc1
s_mov_b32 exec_lo, 0xffffffff
s_mov_b32 exec_hi, 0xffff
global_load_dwordx4 v[20:23], v2, s[70:71] offset:1024 sc1
s_mov_b32 exec_lo, 0xffffffff
s_mov_b32 exec_hi, 0xfff0fff
global_load_dwordx2 v[82:83], v13, s[72:73] sc1
s_mov_b64 exec, -1
s_waitcnt vmcnt(3)
v_max3_u32 v17, v144, v145, v146
v_max3_u32 v17, v17, v147, v148
v_max3_u32 v17, v17, v149, v150
v_max3_u32 v17, v17, v151, v18
v_max_u32 v17, v17, v19
v_cmp_eq_u32 vcc, -1, v17
s_cbranch_vccz L_qx_ok1
s_cmp_eq_u32 s33, 0
s_cbranch_scc1 L_qx_ok0
s_sub_u32 s33, s33, 1
s_branch L_qx
L_qx_ok1:
ds_write_b128 v14, v[144:147]
ds_write_b64 v16, v[18:19]
s_mov_b32 exec_lo, 0xffffffff
s_mov_b32 exec_hi, 0xffff
ds_write_b128 v14, v[148:151] offset:1024
s_mov_b64 exec, -1
s_branch L_qx_w
L_qx_ok0:
ds_write_b128 v14, v[84:87]
ds_write_b64 v16, v[82:83]
s_mov_b32 exec_lo, 0xffffffff
s_mov_b32 exec_hi, 0xffff
ds_write_b128 v14, v[20:23] offset:1024
s_mov_b64 exec, -1
L_qx_w:
s_waitcnt lgkmcnt(0)
L_qx_b:
s_barrier
v_add_u32 v13, 155648, v13
ds_read_b64 v[80:81], v13
ds_read_b128 v[24:27], v12 offset:0
ds_read_b128 v[28:31], v12 offset:64
ds_read_b128 v[32:35], v12 offset:128
ds_read_b128 v[36:39], v12 offset:192
ds_read_b128 v[40:43], v12 offset:256
ds_read_b128 v[44:47], v12 offset:320
ds_read_b128 v[48:51], v12 offset:384
ds_read_b128 v[52:55], v12 offset:448
ds_read_b128 v[56:59], v12 offset:512
ds_read_b128 v[60:63], v12 offset:576
ds_read_b128 v[64:67], v12 offset:640
ds_read_b128 v[68:71], v12 offset:704
ds_read_b128 v[72:75], v12 offset:768
ds_read_b128 v[76:79], v12 offset:832
s_waitcnt lgkmcnt(10)
v_mfma_f32_16x16x32_bf16 v[4:7], v[24:27], v[88:91], 0
v_add_f32_dpp v9, v80, v80 row_ror:8 row_mask:0xf bank_mask:0xf
v_add_f32_dpp v10, v81, v81 row_ror:8 row_mask:0xf bank_mask:0xf
v_mfma_f32_16x16x32_bf16 v[4:7], v[28:31], v[92:95], v[4:7]
v_add_f32_dpp v9, v9, v9 row_ror:4 row_mask:0xf bank_mask:0xf
v_mfma_f32_16x16x32_bf16 v[4:7], v[32:35], v[96:99], v[4:7]
v_add_f32_dpp v10, v10, v10 row_ror:4 row_mask:0xf bank_mask:0xf
v_add_f32_dpp v9, v9, v9 row_ror:2 row_mask:0xf bank_mask:0xf
v_mfma_f32_16x16x32_bf16 v[4:7], v[36:39], v[100:103], v[4:7]
v_add_f32_dpp v10, v10, v10 row_ror:2 row_mask:0xf bank_mask:0xf
s_waitcnt lgkmcnt(6)
v_mfma_f32_16x16x32_bf16 v[4:7], v[40:43], v[104:107], v[4:7]
v_add_f32_dpp v9, v9, v9 row_ror:1 row_mask:0xf bank_mask:0xf
v_add_f32_dpp v10, v10, v10 row_ror:1 row_mask:0xf bank_mask:0xf
v_mfma_f32_16x16x32_bf16 v[4:7], v[44:47], v[108:111], v[4:7]
v_mov_b32 v14, v9
v_mfma_f32_16x16x32_bf16 v[4:7], v[48:51], v[112:115], v[4:7]
v_mov_b32 v15, v10
v_permlane32_swap_b32 v9, v14
v_mfma_f32_16x16x32_bf16 v[4:7], v[52:55], v[116:119], v[4:7]
v_permlane32_swap_b32 v10, v15
s_waitcnt lgkmcnt(2)
v_mfma_f32_16x16x32_bf16 v[4:7], v[56:59], v[120:123], v[4:7]
v_add_f32 v9, v9, v14
v_add_f32 v10, v10, v15
v_mfma_f32_16x16x32_bf16 v[4:7], v[60:63], v[124:127], v[4:7]
v_mul_f32 v9, 0x3b124925, v9
v_mfma_f32_16x16x32_bf16 v[4:7], v[64:67], v[128:131], v[4:7]
v_mul_f32 v10, 0x3b124925, v10
v_fma_f32 v10, -v9, v9, v10
v_mfma_f32_16x16x32_bf16 v[4:7], v[68:71], v[132:135], v[4:7]
v_max_f32 v10, 0, v10
s_waitcnt lgkmcnt(0)
v_mfma_f32_16x16x32_bf16 v[4:7], v[72:75], v[136:139], v[4:7]
v_add_f32 v10, 0x3727c5ac, v10
v_rsq_f32 v10, v10
v_mfma_f32_16x16x32_bf16 v[4:7], v[76:79], v[140:143], v[4:7]
v_mul_f32 v10, 0x3db8aa3b, v10
s_nop 6
v_permlane16_swap_b32 v4, v5
v_fma_f32 v8, -v9, v1, v4
v_mul_f32 v8, v8, v10
s_nop 1
v_mov_b32_dpp v10, v8 quad_perm:[1,0,3,2] row_mask:0xf bank_mask:0xf
v_cvt_pk_bf16_f32 v9, v8, v10
s_mov_b32 exec_lo, 0x55555555
s_mov_b32 exec_hi, 0x0
s_cmp_eq_u32 s32, 1
s_cbranch_scc0 PUBS_31
global_store_dword v11, v9, s[74:75]
PUBD_32:
s_mov_b64 exec, -1
s_waitcnt vmcnt(0)
L_next:
s_cmp_eq_u32 s34, 1
s_cbranch_scc1 L_fin
s_mov_b32 s34, 1
s_branch L_layer
L_final:
s_cmp_eq_u32 s27, 0
s_cbranch_scc0 L_fin
s_mov_b32 exec_lo, 0x55555555
s_mov_b32 exec_hi, 0x55555555
global_store_dword v14, v5, s[16:17]
s_cmp_eq_u32 s7, 2
s_cbranch_scc0 L_noep
s_mov_b64 exec, 1
v_mov_b32 v6, 983040
v_mov_b32 v7, s46
global_store_dword v6, v7, s[20:21]
L_noep:
s_mov_b64 exec, -1
L_fin_w:
L_fin:
L_end:
s_endpgm
PUBS_21:
global_store_dwordx2 v14, v[60:61], s[70:71] sc1
s_branch PUBD_22
PUBS_23:
global_store_dwordx2 v15, v[62:63], s[72:73] sc1
s_branch PUBD_24
PUBS_25:
global_store_dword v14, v5, s[72:73] sc1
s_branch PUBD_26
PUBS_27:
global_store_dwordx2 v15, v[6:7], s[74:75] sc1
s_branch PUBD_28
PUBS_29:
global_store_dword v11, v9, s[74:75] sc1
s_branch PUBD_30
PUBS_31:
global_store_dword v11, v9, s[74:75] sc1
s_branch PUBD_32
.section .rodata,"a"
.p2align 6
.amdhsa_kernel interleave_layers__mha_block_cached__glu_gated_reglu__decode_kernel
  .amdhsa_next_free_vgpr 512
  .amdhsa_next_free_sgpr 102
  .amdhsa_accum_offset 256
  .amdhsa_group_segment_fixed_size 0
  .amdhsa_kernarg_size 96
  .amdhsa_user_sgpr_count 2
  .amdhsa_user_sgpr_kernarg_segment_ptr 1
  .amdhsa_system_sgpr_workgroup_id_x 1
.end_amdhsa_kernel
```
